```python
import torch

def _softmax(x, axis=-1):
    return torch.softmax(x, dim=axis)
def _gelu(x):
    return torch.nn.functional.gelu(x, approximate="tanh")
def _silu(x):
    return torch.nn.functional.silu(x)
def _sigmoid(x):
    return torch.sigmoid(x)
def _layernorm(x, axis=-1, eps=1e-5):
    m = x.mean(dim=axis, keepdim=True)
    v = x.var(dim=axis, keepdim=True, unbiased=False)
    return (x - m) / torch.sqrt(v + eps)
def _scatter_add(tgt, idx, src, axis=0):
    return tgt.clone().index_add_(axis, idx, src)
def _segment_sum(src, seg, n):
    out = torch.zeros((n,) + src.shape[1:], dtype=src.dtype)
    return out.index_add_(0, seg, src)
def _pad(x, pw):
    flat = tuple(v for pair in reversed(pw) for v in pair)
    return torch.nn.functional.pad(x, flat)

kernel_name = 'standalone__gqa_softmax__near_ridge'

def setup_inputs():

    _w = (lambda a: (lambda t: t.to(torch.bfloat16) if t.is_floating_point() else t)(torch.as_tensor(a)))
    B, Hq, Hkv, Sq, Sk, D = 8, 32, 32, 768, 512, 192
    return {
        "q": _w((lambda *s: torch.randn(*s, dtype=torch.bfloat16) * 0.8)(B, Hq, Sq, D)),
        "k": _w((lambda *s: torch.randn(*s, dtype=torch.bfloat16) * 0.8)(B, Hkv, Sk, D)),
        "v": _w((lambda *s: torch.randn(*s, dtype=torch.bfloat16) * 0.05)(B, Hkv, Sk, D)),
    }

def reference(q, k, v):
    B, Hq, Sq, D = q.shape
    Hkv = k.shape[1]
    rep = Hq // Hkv
    k = (lambda x, n, axis: torch.repeat_interleave(x, n, dim=axis))(k, rep, axis=1)
    v = (lambda x, n, axis: torch.repeat_interleave(x, n, dim=axis))(v, rep, axis=1)
    scale = D ** -0.5
    scores = torch.einsum("bhqd,bhkd->bhqk", q, k) * scale
    p = _softmax(scores, axis=-1)
    return torch.einsum("bhqk,bhkd->bhqd", p, v)
```

```asm
; @launch grid=(256,1,1) block=(256,1,1) lds=163840
.amdgcn_target "amdgcn-amd-amdhsa--gfx950"
.text
.globl standalone__gqa_softmax__near_ridge_kernel
.p2align 8
.type standalone__gqa_softmax__near_ridge_kernel,@function
standalone__gqa_softmax__near_ridge_kernel:
    s_cmp_ge_u32 s2, 256
    s_cbranch_scc1 L_end
    s_load_dwordx4 s[4:7], s[0:1], 0
    s_load_dwordx2 s[54:55], s[0:1], 16
    s_load_dwordx2 s[48:49], s[0:1], 24
    s_getpc_b64 s[84:85]
L_pc:
    v_lshlrev_b32 v8, 7, v0
    v_min_u32 v8, CODE_BYTES, v8
    v_mov_b32 v9, s85
    v_add_co_u32 v8, vcc, s84, v8
    s_nop 1
    v_addc_co_u32 v9, vcc, 0, v9, vcc
    global_load_dword v252, v[8:9], off
    v_lshrrev_b32 v6, 6, v0
    v_and_b32 v251, 63, v0
    v_readfirstlane_b32 s24, v6
    v_lshrrev_b32 v6, 3, v251
    v_and_b32 v7, 7, v251
    v_xor_b32 v7, v7, v6
    v_mul_u32_u24 v6, 384, v6
    v_lshl_add_u32 v230, v7, 4, v6
    v_lshrrev_b32 v4, 4, v251
    v_and_b32 v7, 7, v251
    v_xor_b32 v7, v7, v4
    v_lshl_add_u32 v253, v7, 4, v6
    s_mul_i32 s33, s24, 3072
    s_mul_i32 s34, s24, 27648
    s_add_u32 s34, s34, 49152
    s_mov_b32 s29, 0x3dd53b95
    s_and_b32 s38, s2, 7
    s_mul_i32 s38, s38, 96
    s_lshr_b32 s39, s2, 3
    s_add_u32 s50, s38, s39
    s_mov_b32 s11, 0x20000
    s_mov_b32 s15, 0x20000
    s_add_u32 s92, s33, 0
    s_add_u32 s93, s33, 896
    s_add_u32 s94, s33, 1792
    s_mov_b32 s19, 0x20000
    s_mov_b32 s23, 0x20000
    s_mov_b32 s32, s50
    s_mov_b32 s31, 3
    s_mov_b32 s51, 0
    s_mov_b32 s36, 0
    s_mov_b32 s52, 0
    s_mov_b32 s53, 0
    s_waitcnt lgkmcnt(0)
    s_mov_b32 s46, s4
    s_mov_b32 s47, s5
L_run:
    s_mul_hi_u32 s38, s32, 0x55555556
    s_mul_i32 s38, s38, 196608
    s_add_u32 s38, s38, s33
    s_add_u32 s8, s6, s38
    s_addc_u32 s9, s7, 0
    s_mov_b32 s10, 3072
    s_mov_b32 m0, s92
    v_and_b32 v4, 15, v251
    v_lshrrev_b32 v5, 4, v251
    v_lshrrev_b32 v6, 3, v4
    v_mul_u32_u24 v0, 3072, v6
    v_and_b32 v1, 7, v4
    v_lshl_add_u32 v0, v1, 7, v0
    buffer_load_dwordx4 v230, s[8:11], 0 offen offset:0 nt lds
    s_mov_b32 m0, s93
    v_add_u32 v6, 0, v5
    v_xor_b32 v6, v6, v1
    v_lshl_add_u32 v224, v6, 4, v0
    v_add_u32 v244, s34, v224
    v_add_u32 v6, 4, v5
    v_xor_b32 v6, v6, v1
    buffer_load_dwordx4 v230, s[8:11], 0 offen offset:128 nt lds
    s_mov_b32 m0, s94
    v_lshl_add_u32 v225, v6, 4, v0
    v_add_u32 v245, s34, v225
    v_lshrrev_b32 v2, 5, v251
    v_mul_u32_u24 v3, 3072, v2
    v_and_b32 v6, 31, v251
    v_lshl_add_u32 v3, v6, 4, v3
    buffer_load_dwordx4 v230, s[8:11], 0 offen offset:256 nt lds
    s_add_u32 s8, s8, 12288
    s_addc_u32 s9, s9, 0
    s_mul_i32 s39, s32, 98304
    s_mul_i32 s40, s24, 24576
    s_add_u32 s39, s39, s40
    s_add_u32 s16, s46, s39
    s_addc_u32 s17, s47, 0
    s_mov_b32 s18, 6144
    s_add_u32 s12, s54, s38
    s_addc_u32 s13, s55, 0
    s_mov_b32 s14, 3072
    s_add_u32 m0, s34, 0
    v_add_u32 v3, s34, v3
    v_add_u32 v246, 3072, v3
    v_lshrrev_b32 v6, 3, v251
    v_mul_u32_u24 v6, 384, v6
    v_and_b32 v7, 7, v251
    v_lshl_add_u32 v247, v7, 4, v6
    buffer_load_dwordx4 v230, s[16:19], 0 offen offset:0 nt lds
    s_add_u32 m0, s34, 896
    v_lshlrev_b32 v3, 8, v2
    v_and_b32 v6, 1, v5
    v_lshl_add_u32 v3, v6, 9, v3
    v_and_b32 v6, 1, v251
    v_lshl_add_u32 v3, v6, 7, v3
    v_bfe_u32 v6, v251, 2, 2
    buffer_load_dwordx4 v230, s[16:19], 0 offen offset:128 nt lds
    s_add_u32 m0, s34, 1792
    v_lshl_add_u32 v3, v6, 4, v3
    v_bfe_u32 v6, v251, 1, 1
    v_lshl_add_u32 v3, v6, 3, v3
    v_add_u32 v3, s34, v3
    v_add_u32 v250, 3072, v3
    v_mov_b32 v6, s24
    buffer_load_dwordx4 v230, s[16:19], 0 offen offset:256 nt lds
    s_add_u32 s16, s16, 3072
    s_addc_u32 s17, s17, 0
    s_add_u32 m0, s34, 3072
    v_lshlrev_b32 v6, 8, v6
    v_add_u32 v6, 160000, v6
    v_lshl_add_u32 v248, v251, 2, v6
    v_lshl_add_u32 v249, v5, 4, v6
    v_lshrrev_b32 v7, 2, v251
    v_lshrrev_b32 v6, 3, v7
    buffer_load_dwordx4 v230, s[16:19], 0 offen offset:0 nt lds
    s_add_u32 m0, s34, 3968
    v_mul_u32_u24 v0, 3072, v6
    v_and_b32 v1, 7, v7
    v_lshl_add_u32 v0, v1, 7, v0
    v_and_b32 v6, 1, v251
    v_lshl_add_u32 v0, v6, 3, v0
    v_bfe_u32 v2, v251, 1, 1
    buffer_load_dwordx4 v230, s[16:19], 0 offen offset:128 nt lds
    s_add_u32 m0, s34, 4864
    v_lshl_add_u32 v0, v2, 6, v0
    v_lshrrev_b32 v1, 1, v1
    v_xor_b32 v6, 0, v1
    v_lshl_add_u32 v226, v6, 4, v0
    v_xor_b32 v6, 1, v1
    v_lshl_add_u32 v227, v6, 4, v0
    buffer_load_dwordx4 v230, s[16:19], 0 offen offset:256 nt lds
    s_add_u32 s16, s16, 3072
    s_addc_u32 s17, s17, 0
    s_add_u32 s95, s33, 12288
    s_add_u32 s96, s33, 13184
    s_add_u32 s97, s33, 14080
    s_add_u32 s98, s33, 24576
    s_add_u32 s99, s33, 25472
    s_add_u32 s100, s33, 26368
    s_add_u32 s101, s33, 36864
    s_add_u32 s37, s33, 37760
    s_add_u32 s3, s33, 38656
    s_add_u32 m0, s34, 6144
    v_xor_b32 v6, 2, v1
    v_lshl_add_u32 v228, v6, 4, v0
    v_xor_b32 v6, 3, v1
    v_lshl_add_u32 v229, v6, 4, v0
    v_mov_b32 v232, 0xff800000
    v_mov_b32 v236, 0
    buffer_load_dwordx4 v230, s[16:19], 0 offen offset:0 nt lds
    s_add_u32 m0, s34, 7040
    v_mov_b32 v233, 0xff800000
    v_mov_b32 v237, 0
    v_mov_b32 v234, 0xff800000
    v_mov_b32 v238, 0
    v_mov_b32 v235, 0xff800000
    v_mov_b32 v239, 0
    buffer_load_dwordx4 v230, s[16:19], 0 offen offset:128 nt lds
    s_mov_b32 s20, s48
    s_mov_b32 s21, s49
    s_mov_b32 s22, 0
    v_add_u32 v231, 3072, v250
    s_add_u32 s42, s50, 64
    s_mul_i32 s39, s42, 98304
    s_mul_i32 s40, s24, 24576
    s_add_u32 s39, s39, s40
    s_add_u32 s84, s46, s39
    s_addc_u32 s85, s47, 0
    s_cmp_eq_u32 s31, 3
    s_cselect_b32 s86, 2048, 0
    s_mov_b32 s87, 0x20000
    s_mov_b32 s0, 4096
    s_mov_b32 s1, 5
    s_cmp_lg_u32 s52, 0
    s_cbranch_scc1 L_max
L_k0:
    s_waitcnt vmcnt(8) lgkmcnt(0)
    s_barrier
    ds_read_b128 a[208:211], v224 offset:0
    ds_read_b128 a[212:215], v225 offset:0
    ds_read_b128 a[216:219], v224 offset:1024
    ds_read_b128 a[220:223], v225 offset:1024
    ds_read_b128 a[224:227], v224 offset:2048
    ds_read_b128 a[228:231], v225 offset:2048
    ds_read_b128 a[232:235], v224 offset:6144
    ds_read_b128 a[236:239], v225 offset:6144
    ds_read_b128 a[240:243], v224 offset:7168
    ds_read_b128 a[244:247], v225 offset:7168
    ds_read_b128 a[248:251], v224 offset:8192
    ds_read_b128 a[252:255], v225 offset:8192
    v_lshlrev_b32 v254, 7, v251
    s_add_u32 m0, s34, 7936
    s_nop 0
    buffer_load_dwordx4 v230, s[16:19], 0 offen offset:256 nt lds
    s_add_u32 s16, s16, 3072
    s_addc_u32 s17, s17, 0
    s_add_u32 m0, s34, 9216
    s_nop 0
    buffer_load_dwordx4 v230, s[16:19], 0 offen offset:0 nt lds
    s_add_u32 m0, s34, 10112
    s_nop 0
    buffer_load_dwordx4 v230, s[16:19], 0 offen offset:128 nt lds
    s_add_u32 m0, s34, 11008
    s_nop 0
    buffer_load_dwordx4 v230, s[16:19], 0 offen offset:256 nt lds
    s_add_u32 s16, s16, 3072
    s_addc_u32 s17, s17, 0
    s_mov_b32 m0, s95
    s_nop 0
    buffer_load_dwordx4 v230, s[8:11], 0 offen offset:0 nt lds
    s_waitcnt vmcnt(7)
    ds_read_b128 a[0:3], v244 offset:0
    ds_read_b128 a[4:7], v245 offset:0
    ds_read_b128 a[8:11], v244 offset:1024
    ds_read_b128 a[12:15], v245 offset:1024
    ds_read_b128 a[16:19], v244 offset:2048
    ds_read_b128 a[20:23], v245 offset:2048
    s_waitcnt lgkmcnt(5)
    v_mfma_f32_16x16x32_bf16 v[176:179], a[208:211], a[0:3], 0
    s_waitcnt lgkmcnt(4)
    v_mfma_f32_16x16x32_bf16 v[176:179], a[212:215], a[4:7], v[176:179]
    s_waitcnt lgkmcnt(3)
    v_mfma_f32_16x16x32_bf16 v[176:179], a[216:219], a[8:11], v[176:179]
    s_waitcnt lgkmcnt(2)
    v_mfma_f32_16x16x32_bf16 v[176:179], a[220:223], a[12:15], v[176:179]
    s_waitcnt lgkmcnt(1)
    v_mfma_f32_16x16x32_bf16 v[176:179], a[224:227], a[16:19], v[176:179]
    s_waitcnt lgkmcnt(0)
    v_mfma_f32_16x16x32_bf16 v[176:179], a[228:231], a[20:23], v[176:179]
    v_mfma_f32_16x16x32_bf16 v[180:183], a[232:235], a[0:3], 0
    v_mfma_f32_16x16x32_bf16 v[180:183], a[236:239], a[4:7], v[180:183]
    v_mfma_f32_16x16x32_bf16 v[180:183], a[240:243], a[8:11], v[180:183]
    v_mfma_f32_16x16x32_bf16 v[180:183], a[244:247], a[12:15], v[180:183]
    v_mfma_f32_16x16x32_bf16 v[180:183], a[248:251], a[16:19], v[180:183]
    v_mfma_f32_16x16x32_bf16 v[180:183], a[252:255], a[20:23], v[180:183]
    v_mov_b32 v240, v236
    s_nop 0
    v_max3_f32 v232, v232, v176, v177
    v_max3_f32 v232, v232, v178, v179
    s_nop 3
    v_max3_f32 v232, v232, v180, v181
    v_max3_f32 v232, v232, v182, v183
    v_mov_b32 v236, v232
    s_nop 0
    s_nop 0
    v_permlane32_swap_b32 v232, v236
    v_max_f32 v232, v232, v236
    v_mov_b32 v236, v232
    s_nop 0
    s_nop 0
    v_permlane16_swap_b32 v232, v236
    v_max_f32 v232, v232, v236
    v_mul_f32 v232, s29, v232
    v_fma_f32 v176, v176, s29, -v232
    v_fma_f32 v177, v177, s29, -v232
    v_fma_f32 v178, v178, s29, -v232
    v_fma_f32 v179, v179, s29, -v232
    v_fma_f32 v180, v180, s29, -v232
    v_fma_f32 v181, v181, s29, -v232
    v_fma_f32 v182, v182, s29, -v232
    v_fma_f32 v183, v183, s29, -v232
    v_exp_f32 v176, v176
    v_exp_f32 v177, v177
    v_exp_f32 v178, v178
    v_exp_f32 v179, v179
    v_exp_f32 v180, v180
    v_exp_f32 v181, v181
    v_exp_f32 v182, v182
    v_exp_f32 v183, v183
    v_add_f32 v236, v176, v177
    v_cvt_pk_bf16_f32 v208, v176, v177
    v_cvt_pk_bf16_f32 v209, v178, v179
    v_add_f32 v236, v236, v178
    v_cvt_pk_bf16_f32 v210, v180, v181
    v_cvt_pk_bf16_f32 v211, v182, v183
    v_add_f32 v236, v236, v179
    v_add_f32 v236, v236, v180
    v_add_f32 v236, v236, v181
    v_add_f32 v236, v236, v182
    v_add_f32 v236, v236, v183
    s_mov_b32 m0, s96
    s_nop 0
    buffer_load_dwordx4 v230, s[8:11], 0 offen offset:128 nt lds
    s_mov_b32 m0, s97
    s_nop 0
    buffer_load_dwordx4 v230, s[8:11], 0 offen offset:256 nt lds
    s_add_u32 s8, s8, 12288
    s_addc_u32 s9, s9, 0
    s_mov_b32 m0, s98
    s_nop 0
    buffer_load_dwordx4 v253, s[12:15], 0 offen offset:0 nt lds
    s_mov_b32 m0, s99
    s_nop 0
    buffer_load_dwordx4 v253, s[12:15], 0 offen offset:128 nt lds
    s_mov_b32 m0, s100
    s_nop 0
    buffer_load_dwordx4 v253, s[12:15], 0 offen offset:256 nt lds
    s_add_u32 s12, s12, 12288
    s_addc_u32 s13, s13, 0
    s_add_u32 m0, s34, 12288
    s_nop 0
    buffer_load_dwordx4 v230, s[16:19], 0 offen offset:0 nt lds
    s_waitcnt vmcnt(7)
    ds_read_b128 a[24:27], v244 offset:6144
    ds_read_b128 a[28:31], v245 offset:6144
    ds_read_b128 a[32:35], v244 offset:7168
    ds_read_b128 a[36:39], v245 offset:7168
    ds_read_b128 a[40:43], v244 offset:8192
    ds_read_b128 a[44:47], v245 offset:8192
    s_waitcnt lgkmcnt(5)
    v_mfma_f32_16x16x32_bf16 v[184:187], a[208:211], a[24:27], 0
    s_waitcnt lgkmcnt(4)
    v_mfma_f32_16x16x32_bf16 v[184:187], a[212:215], a[28:31], v[184:187]
    s_waitcnt lgkmcnt(3)
    v_mfma_f32_16x16x32_bf16 v[184:187], a[216:219], a[32:35], v[184:187]
    s_waitcnt lgkmcnt(2)
    v_mfma_f32_16x16x32_bf16 v[184:187], a[220:223], a[36:39], v[184:187]
    s_waitcnt lgkmcnt(1)
    v_mfma_f32_16x16x32_bf16 v[184:187], a[224:227], a[40:43], v[184:187]
    s_waitcnt lgkmcnt(0)
    v_mfma_f32_16x16x32_bf16 v[184:187], a[228:231], a[44:47], v[184:187]
    v_mfma_f32_16x16x32_bf16 v[188:191], a[232:235], a[24:27], 0
    v_mfma_f32_16x16x32_bf16 v[188:191], a[236:239], a[28:31], v[188:191]
    v_mfma_f32_16x16x32_bf16 v[188:191], a[240:243], a[32:35], v[188:191]
    v_mfma_f32_16x16x32_bf16 v[188:191], a[244:247], a[36:39], v[188:191]
    v_mfma_f32_16x16x32_bf16 v[188:191], a[248:251], a[40:43], v[188:191]
    v_mfma_f32_16x16x32_bf16 v[188:191], a[252:255], a[44:47], v[188:191]
    v_mov_b32 v241, v237
    s_nop 0
    v_max3_f32 v233, v233, v184, v185
    v_max3_f32 v233, v233, v186, v187
    s_nop 3
    v_max3_f32 v233, v233, v188, v189
    v_max3_f32 v233, v233, v190, v191
    v_mov_b32 v237, v233
    s_nop 0
    s_nop 0
    v_permlane32_swap_b32 v233, v237
    v_max_f32 v233, v233, v237
    v_mov_b32 v237, v233
    s_nop 0
    s_nop 0
    v_permlane16_swap_b32 v233, v237
    v_max_f32 v233, v233, v237
    v_mul_f32 v233, s29, v233
    v_fma_f32 v184, v184, s29, -v233
    v_fma_f32 v185, v185, s29, -v233
    v_fma_f32 v186, v186, s29, -v233
    v_fma_f32 v187, v187, s29, -v233
    v_fma_f32 v188, v188, s29, -v233
    v_fma_f32 v189, v189, s29, -v233
    v_fma_f32 v190, v190, s29, -v233
    v_fma_f32 v191, v191, s29, -v233
    v_exp_f32 v184, v184
    v_exp_f32 v185, v185
    v_exp_f32 v186, v186
    v_exp_f32 v187, v187
    v_exp_f32 v188, v188
    v_exp_f32 v189, v189
    v_exp_f32 v190, v190
    v_exp_f32 v191, v191
    v_add_f32 v237, v184, v185
    v_cvt_pk_bf16_f32 v212, v184, v185
    v_cvt_pk_bf16_f32 v213, v186, v187
    v_add_f32 v237, v237, v186
    v_cvt_pk_bf16_f32 v214, v188, v189
    v_cvt_pk_bf16_f32 v215, v190, v191
    v_add_f32 v237, v237, v187
    v_add_f32 v237, v237, v188
    v_add_f32 v237, v237, v189
    v_add_f32 v237, v237, v190
    v_add_f32 v237, v237, v191
    s_add_u32 m0, s34, 13184
    s_nop 0
    buffer_load_dwordx4 v230, s[16:19], 0 offen offset:128 nt lds
    s_add_u32 m0, s34, 14080
    s_nop 0
    buffer_load_dwordx4 v230, s[16:19], 0 offen offset:256 nt lds
    s_add_u32 s16, s16, 3072
    s_addc_u32 s17, s17, 0
    s_add_u32 m0, s34, 15360
    s_nop 0
    buffer_load_dwordx4 v230, s[16:19], 0 offen offset:0 nt lds
    s_add_u32 m0, s34, 16256
    s_nop 0
    buffer_load_dwordx4 v230, s[16:19], 0 offen offset:128 nt lds
    s_add_u32 m0, s34, 17152
    s_nop 0
    buffer_load_dwordx4 v230, s[16:19], 0 offen offset:256 nt lds
    s_add_u32 s16, s16, 3072
    s_addc_u32 s17, s17, 0
    s_add_u32 m0, s34, 18432
    s_nop 0
    buffer_load_dwordx4 v230, s[16:19], 0 offen offset:0 nt lds
    s_waitcnt vmcnt(7)
    s_barrier
    ds_read_b128 a[96:99], v224 offset:12288
    ds_read_b128 a[100:103], v225 offset:12288
    ds_read_b128 a[104:107], v224 offset:13312
    ds_read_b128 a[108:111], v225 offset:13312
    ds_read_b128 a[112:115], v224 offset:14336
    ds_read_b128 a[116:119], v225 offset:14336
    ds_read_b128 a[120:123], v224 offset:18432
    ds_read_b128 a[124:127], v225 offset:18432
    ds_read_b128 a[128:131], v224 offset:19456
    ds_read_b128 a[132:135], v225 offset:19456
    ds_read_b128 a[136:139], v224 offset:20480
    ds_read_b128 a[140:143], v225 offset:20480
    ds_read_b64_tr_b16 a[144:145], v226 offset:24576
    ds_read_b64_tr_b16 a[146:147], v226 offset:30720
    ds_read_b64_tr_b16 a[148:149], v227 offset:24576
    ds_read_b64_tr_b16 a[150:151], v227 offset:30720
    ds_read_b64_tr_b16 a[152:153], v228 offset:24576
    ds_read_b64_tr_b16 a[154:155], v228 offset:30720
    ds_read_b64_tr_b16 a[156:157], v229 offset:24576
    ds_read_b64_tr_b16 a[158:159], v229 offset:30720
    ds_read_b64_tr_b16 a[160:161], v226 offset:25600
    ds_read_b64_tr_b16 a[162:163], v226 offset:31744
    ds_read_b64_tr_b16 a[164:165], v227 offset:25600
    ds_read_b64_tr_b16 a[166:167], v227 offset:31744
    s_mul_hi_u32 s38, s32, 0x55555556
    s_mul_i32 s38, s38, 196608
    s_add_u32 s38, s38, s33
    s_add_u32 s38, s38, 196608
    s_add_u32 s25, s6, s38
    s_add_u32 s26, s54, s38
    s_add_u32 s41, s32, 32
    s_min_u32 s41, s41, 767
    s_mul_hi_u32 s38, s41, 0x55555556
    s_mul_i32 s38, s38, 196608
    s_add_u32 s38, s38, s33
    s_add_u32 s88, s6, s38
    s_addc_u32 s89, s7, 0
    ds_read_b64_tr_b16 a[168:169], v228 offset:25600
    ds_read_b64_tr_b16 a[170:171], v228 offset:31744
    ds_read_b64_tr_b16 a[172:173], v229 offset:25600
    ds_read_b64_tr_b16 a[174:175], v229 offset:31744
    ds_read_b64_tr_b16 a[176:177], v226 offset:26624
    ds_read_b64_tr_b16 a[178:179], v226 offset:32768
    ds_read_b64_tr_b16 a[180:181], v227 offset:26624
    ds_read_b64_tr_b16 a[182:183], v227 offset:32768
    ds_read_b64_tr_b16 a[184:185], v228 offset:26624
    ds_read_b64_tr_b16 a[186:187], v228 offset:32768
    ds_read_b64_tr_b16 a[188:189], v229 offset:26624
    ds_read_b64_tr_b16 a[190:191], v229 offset:32768
    s_waitcnt lgkmcnt(15)
    v_mfma_f32_16x16x32_bf16 v[176:179], a[96:99], a[0:3], 0
    v_mfma_f32_16x16x32_bf16 v[176:179], a[100:103], a[4:7], v[176:179]
    v_mfma_f32_16x16x32_bf16 v[176:179], a[104:107], a[8:11], v[176:179]
    v_mfma_f32_16x16x32_bf16 v[176:179], a[108:111], a[12:15], v[176:179]
    v_mfma_f32_16x16x32_bf16 v[176:179], a[112:115], a[16:19], v[176:179]
    v_mfma_f32_16x16x32_bf16 v[176:179], a[116:119], a[20:23], v[176:179]
    v_mfma_f32_16x16x32_bf16 v[180:183], a[120:123], a[0:3], 0
    v_mfma_f32_16x16x32_bf16 v[180:183], a[124:127], a[4:7], v[180:183]
    v_mfma_f32_16x16x32_bf16 v[180:183], a[128:131], a[8:11], v[180:183]
    s_add_u32 m0, s34, 19328
    s_nop 0
    buffer_load_dwordx4 v230, s[16:19], 0 offen offset:128 nt lds
    v_mfma_f32_16x16x32_bf16 v[180:183], a[132:135], a[12:15], v[180:183]
    v_mfma_f32_16x16x32_bf16 v[180:183], a[136:139], a[16:19], v[180:183]
    v_mfma_f32_16x16x32_bf16 v[180:183], a[140:143], a[20:23], v[180:183]
    s_waitcnt lgkmcnt(0)
    s_barrier
    v_mfma_f32_16x16x32_bf16 v[0:3], v[208:211], a[144:147], 0
    v_mfma_f32_16x16x32_bf16 v[4:7], v[208:211], a[148:151], 0
    v_mfma_f32_16x16x32_bf16 v[8:11], v[208:211], a[152:155], 0
    v_mfma_f32_16x16x32_bf16 v[12:15], v[208:211], a[156:159], 0
    v_fma_f32 v176, v176, s29, -v232
    v_fma_f32 v177, v177, s29, -v232
    v_mfma_f32_16x16x32_bf16 v[16:19], v[208:211], a[160:163], 0
    v_fma_f32 v178, v178, s29, -v232
    v_mfma_f32_16x16x32_bf16 v[20:23], v[208:211], a[164:167], 0
    v_exp_f32 v176, v176
    v_mfma_f32_16x16x32_bf16 v[24:27], v[208:211], a[168:171], 0
    s_add_u32 m0, s34, 20224
    s_nop 0
    buffer_load_dwordx4 v230, s[16:19], 0 offen offset:256 nt lds
    s_add_u32 s16, s16, 3072
    s_addc_u32 s17, s17, 0
    v_exp_f32 v177, v177
    v_mfma_f32_16x16x32_bf16 v[28:31], v[208:211], a[172:175], 0
    v_exp_f32 v178, v178
    v_mfma_f32_16x16x32_bf16 v[32:35], v[208:211], a[176:179], 0
    v_add_f32 v236, v236, v176
    v_fma_f32 v179, v179, s29, -v232
    v_mfma_f32_16x16x32_bf16 v[36:39], v[208:211], a[180:183], 0
    v_add_f32 v236, v236, v177
    v_fma_f32 v180, v180, s29, -v232
    v_mfma_f32_16x16x32_bf16 v[40:43], v[208:211], a[184:187], 0
    v_exp_f32 v179, v179
    v_mfma_f32_16x16x32_bf16 a[192:195], v[208:211], a[188:191], 0
    v_add_f32 v236, v236, v178
    v_mfma_f32_16x16x32_bf16 v[184:187], a[96:99], a[24:27], 0
    v_exp_f32 v180, v180
    v_mfma_f32_16x16x32_bf16 v[184:187], a[100:103], a[28:31], v[184:187]
    s_add_u32 m0, s34, 21504
    s_nop 0
    buffer_load_dwordx4 v230, s[16:19], 0 offen offset:0 nt lds
    v_add_f32 v236, v236, v179
    v_fma_f32 v181, v181, s29, -v232
    v_mfma_f32_16x16x32_bf16 v[184:187], a[104:107], a[32:35], v[184:187]
    v_fma_f32 v182, v182, s29, -v232
    v_add_f32 v236, v236, v180
    v_mfma_f32_16x16x32_bf16 v[184:187], a[108:111], a[36:39], v[184:187]
    v_exp_f32 v181, v181
    v_mfma_f32_16x16x32_bf16 v[184:187], a[112:115], a[40:43], v[184:187]
    v_exp_f32 v182, v182
    v_mfma_f32_16x16x32_bf16 v[184:187], a[116:119], a[44:47], v[184:187]
    v_fma_f32 v183, v183, s29, -v232
    v_add_f32 v236, v236, v181
    v_mfma_f32_16x16x32_bf16 v[188:191], a[120:123], a[24:27], 0
    v_exp_f32 v183, v183
    v_mfma_f32_16x16x32_bf16 v[188:191], a[124:127], a[28:31], v[188:191]
    v_add_f32 v236, v236, v182
    s_add_u32 m0, s34, 22400
    s_nop 0
    buffer_load_dwordx4 v230, s[16:19], 0 offen offset:128 nt lds
    v_add_f32 v236, v236, v183
    v_mfma_f32_16x16x32_bf16 v[188:191], a[128:131], a[32:35], v[188:191]
    v_mfma_f32_16x16x32_bf16 v[188:191], a[132:135], a[36:39], v[188:191]
    v_mfma_f32_16x16x32_bf16 v[188:191], a[136:139], a[40:43], v[188:191]
    v_mfma_f32_16x16x32_bf16 v[188:191], a[140:143], a[44:47], v[188:191]
    v_mfma_f32_16x16x32_bf16 v[44:47], v[212:215], a[144:147], 0
    v_cvt_pk_bf16_f32 v208, v176, v177
    v_cvt_pk_bf16_f32 v209, v178, v179
    v_mfma_f32_16x16x32_bf16 v[48:51], v[212:215], a[148:151], 0
    v_cvt_pk_bf16_f32 v210, v180, v181
    v_cvt_pk_bf16_f32 v211, v182, v183
    v_mfma_f32_16x16x32_bf16 v[52:55], v[212:215], a[152:155], 0
    v_fma_f32 v184, v184, s29, -v233
    v_fma_f32 v185, v185, s29, -v233
    v_mfma_f32_16x16x32_bf16 v[56:59], v[212:215], a[156:159], 0
    v_fma_f32 v186, v186, s29, -v233
    s_add_u32 m0, s34, 23296
    s_nop 0
    buffer_load_dwordx4 v230, s[16:19], 0 offen offset:256 nt lds
    s_add_u32 s16, s16, 3072
    s_addc_u32 s17, s17, 0
    v_mfma_f32_16x16x32_bf16 v[60:63], v[212:215], a[160:163], 0
    v_exp_f32 v184, v184
    v_mfma_f32_16x16x32_bf16 v[64:67], v[212:215], a[164:167], 0
    v_exp_f32 v185, v185
    v_mfma_f32_16x16x32_bf16 v[68:71], v[212:215], a[168:171], 0
    v_exp_f32 v186, v186
    v_mfma_f32_16x16x32_bf16 v[72:75], v[212:215], a[172:175], 0
    v_add_f32 v237, v237, v184
    v_fma_f32 v187, v187, s29, -v233
    v_mfma_f32_16x16x32_bf16 v[76:79], v[212:215], a[176:179], 0
    v_add_f32 v237, v237, v185
    v_fma_f32 v188, v188, s29, -v233
    v_mfma_f32_16x16x32_bf16 v[80:83], v[212:215], a[180:183], 0
    v_exp_f32 v187, v187
    v_mfma_f32_16x16x32_bf16 v[84:87], v[212:215], a[184:187], 0
    v_add_f32 v237, v237, v186
    v_mfma_f32_16x16x32_bf16 a[196:199], v[212:215], a[188:191], 0
    v_exp_f32 v188, v188
    v_add_f32 v237, v237, v187
    v_fma_f32 v189, v189, s29, -v233
    v_fma_f32 v190, v190, s29, -v233
    v_add_f32 v237, v237, v188
    v_exp_f32 v189, v189
    v_exp_f32 v190, v190
    v_fma_f32 v191, v191, s29, -v233
    v_add_f32 v237, v237, v189
    v_exp_f32 v191, v191
    v_add_f32 v237, v237, v190
    v_add_f32 v237, v237, v191
    v_cvt_pk_bf16_f32 v212, v184, v185
    v_cvt_pk_bf16_f32 v213, v186, v187
    v_cvt_pk_bf16_f32 v214, v188, v189
    v_cvt_pk_bf16_f32 v215, v190, v191
    s_mov_b32 m0, s92
    s_nop 0
    buffer_load_dwordx4 v230, s[8:11], 0 offen offset:0 nt lds
    s_mov_b32 m0, s93
    s_nop 0
    buffer_load_dwordx4 v230, s[8:11], 0 offen offset:128 nt lds
    s_mov_b32 m0, s94
    s_nop 0
    buffer_load_dwordx4 v230, s[8:11], 0 offen offset:256 nt lds
    s_add_u32 s8, s8, 12288
    s_addc_u32 s9, s9, 0
    s_add_u32 s90, s54, s38
    s_addc_u32 s91, s55, 0
    s_mul_i32 s39, s41, 98304
    s_mul_i32 s40, s24, 24576
    s_add_u32 s39, s39, s40
    s_add_u32 s16, s46, s39
    s_addc_u32 s17, s47, 0
    s_cmp_gt_u32 s31, 1
    s_cselect_b32 s27, 3072, 0
    s_cselect_b32 s18, 6144, 0
    s_mov_b32 s28, 0
    s_mov_b32 s35, s34
    s_mov_b32 s30, 7
    s_waitcnt vmcnt(9)
    ds_read_b128 a[48:51], v244 offset:12288
    ds_read_b128 a[52:55], v245 offset:12288
    ds_read_b128 a[56:59], v244 offset:13312
    ds_read_b128 a[60:63], v245 offset:13312
    ds_read_b128 a[64:67], v244 offset:14336
    ds_read_b128 a[68:71], v245 offset:14336
    s_waitcnt lgkmcnt(5)
    v_mfma_f32_16x16x32_bf16 v[124:127], a[208:211], a[48:51], 0
    s_mov_b32 m0, s101
    s_nop 0
    buffer_load_dwordx4 v253, s[12:15], 0 offen offset:0 nt lds
    s_waitcnt lgkmcnt(4)
    v_mfma_f32_16x16x32_bf16 v[124:127], a[212:215], a[52:55], v[124:127]
    s_waitcnt lgkmcnt(3)
    v_mfma_f32_16x16x32_bf16 v[124:127], a[216:219], a[56:59], v[124:127]
    s_waitcnt lgkmcnt(2)
    v_mfma_f32_16x16x32_bf16 v[124:127], a[220:223], a[60:63], v[124:127]
    s_waitcnt lgkmcnt(1)
    v_mfma_f32_16x16x32_bf16 v[124:127], a[224:227], a[64:67], v[124:127]
    s_waitcnt lgkmcnt(0)
    v_mfma_f32_16x16x32_bf16 v[124:127], a[228:231], a[68:71], v[124:127]
    v_mfma_f32_16x16x32_bf16 v[128:131], a[232:235], a[48:51], 0
    v_mfma_f32_16x16x32_bf16 v[128:131], a[236:239], a[52:55], v[128:131]
    v_mfma_f32_16x16x32_bf16 v[128:131], a[240:243], a[56:59], v[128:131]
    v_mfma_f32_16x16x32_bf16 v[128:131], a[244:247], a[60:63], v[128:131]
    v_mfma_f32_16x16x32_bf16 v[128:131], a[248:251], a[64:67], v[128:131]
    v_mfma_f32_16x16x32_bf16 v[128:131], a[252:255], a[68:71], v[128:131]
    v_mfma_f32_16x16x32_bf16 v[192:195], a[96:99], a[48:51], 0
    v_mfma_f32_16x16x32_bf16 v[192:195], a[100:103], a[52:55], v[192:195]
    v_mfma_f32_16x16x32_bf16 v[192:195], a[104:107], a[56:59], v[192:195]
    v_mfma_f32_16x16x32_bf16 v[192:195], a[108:111], a[60:63], v[192:195]
    v_mov_b32 v242, v238
    v_max3_f32 v234, v234, v124, v125
    v_mfma_f32_16x16x32_bf16 v[192:195], a[112:115], a[64:67], v[192:195]
    v_max3_f32 v234, v234, v126, v127
    s_mov_b32 m0, s37
    s_nop 0
    buffer_load_dwordx4 v253, s[12:15], 0 offen offset:128 nt lds
    v_max3_f32 v234, v234, v128, v129
    v_mfma_f32_16x16x32_bf16 v[192:195], a[116:119], a[68:71], v[192:195]
    v_max3_f32 v234, v234, v130, v131
    v_mov_b32 v238, v234
    v_mfma_f32_16x16x32_bf16 v[196:199], a[120:123], a[48:51], 0
    s_nop 0
    v_permlane32_swap_b32 v234, v238
    v_max_f32 v234, v234, v238
    v_mfma_f32_16x16x32_bf16 v[196:199], a[124:127], a[52:55], v[196:199]
    v_mov_b32 v238, v234
    s_nop 1
    v_permlane16_swap_b32 v234, v238
    v_mfma_f32_16x16x32_bf16 v[196:199], a[128:131], a[56:59], v[196:199]
    v_max_f32 v234, v234, v238
    v_mul_f32 v234, s29, v234
    v_mfma_f32_16x16x32_bf16 v[196:199], a[132:135], a[60:63], v[196:199]
    v_fma_f32 v124, v124, s29, -v234
    v_fma_f32 v125, v125, s29, -v234
    v_mfma_f32_16x16x32_bf16 v[196:199], a[136:139], a[64:67], v[196:199]
    v_fma_f32 v126, v126, s29, -v234
    v_fma_f32 v127, v127, s29, -v234
    v_mfma_f32_16x16x32_bf16 v[196:199], a[140:143], a[68:71], v[196:199]
    v_fma_f32 v128, v128, s29, -v234
    v_fma_f32 v129, v129, s29, -v234
    v_fma_f32 v130, v130, s29, -v234
    v_fma_f32 v131, v131, s29, -v234
    s_mov_b32 m0, s3
    s_nop 0
    buffer_load_dwordx4 v253, s[12:15], 0 offen offset:256 nt lds
    s_add_u32 s12, s12, 12288
    s_addc_u32 s13, s13, 0
    v_exp_f32 v124, v124
    v_exp_f32 v125, v125
    v_exp_f32 v126, v126
    v_exp_f32 v127, v127
    v_exp_f32 v128, v128
    v_exp_f32 v129, v129
    v_exp_f32 v130, v130
    v_exp_f32 v131, v131
    v_add_f32 v238, v124, v125
    v_cvt_pk_bf16_f32 v216, v124, v125
    v_cvt_pk_bf16_f32 v217, v126, v127
    v_add_f32 v238, v238, v126
    v_cvt_pk_bf16_f32 v218, v128, v129
    v_cvt_pk_bf16_f32 v219, v130, v131
    v_add_f32 v238, v238, v127
    v_add_f32 v238, v238, v128
    v_add_f32 v238, v238, v129
    v_add_f32 v238, v238, v130
    v_add_f32 v238, v238, v131
    v_mfma_f32_16x16x32_bf16 v[88:91], v[216:219], a[144:147], 0
    v_fma_f32 v192, v192, s29, -v234
    v_fma_f32 v193, v193, s29, -v234
    v_mfma_f32_16x16x32_bf16 v[92:95], v[216:219], a[148:151], 0
    v_fma_f32 v194, v194, s29, -v234
    v_mfma_f32_16x16x32_bf16 v[96:99], v[216:219], a[152:155], 0
    v_exp_f32 v192, v192
    v_mfma_f32_16x16x32_bf16 v[100:103], v[216:219], a[156:159], 0
    v_exp_f32 v193, v193
    v_mfma_f32_16x16x32_bf16 v[104:107], v[216:219], a[160:163], 0
    v_exp_f32 v194, v194
    v_mfma_f32_16x16x32_bf16 v[108:111], v[216:219], a[164:167], 0
    v_add_f32 v238, v238, v192
    v_fma_f32 v195, v195, s29, -v234
    v_mfma_f32_16x16x32_bf16 v[112:115], v[216:219], a[168:171], 0
    v_add_f32 v238, v238, v193
    v_fma_f32 v196, v196, s29, -v234
    v_mfma_f32_16x16x32_bf16 v[116:119], v[216:219], a[172:175], 0
    v_exp_f32 v195, v195
    v_mfma_f32_16x16x32_bf16 v[120:123], v[216:219], a[176:179], 0
    v_add_f32 v238, v238, v194
    v_mfma_f32_16x16x32_bf16 v[124:127], v[216:219], a[180:183], 0
    v_exp_f32 v196, v196
    v_mfma_f32_16x16x32_bf16 v[128:131], v[216:219], a[184:187], 0
    v_add_f32 v238, v238, v195
    v_fma_f32 v197, v197, s29, -v234
    v_mfma_f32_16x16x32_bf16 a[200:203], v[216:219], a[188:191], 0
    v_fma_f32 v198, v198, s29, -v234
    v_fma_f32 v199, v199, s29, -v234
    v_exp_f32 v197, v197
    v_cvt_pk_bf16_f32 v216, v192, v193
    v_cvt_pk_bf16_f32 v217, v194, v195
    s_waitcnt vmcnt(6)
    ds_read_b128 a[72:75], v244 offset:18432
    ds_read_b128 a[76:79], v245 offset:18432
    ds_read_b128 a[80:83], v244 offset:19456
    ds_read_b128 a[84:87], v245 offset:19456
    ds_read_b128 a[88:91], v244 offset:20480
    ds_read_b128 a[92:95], v245 offset:20480
    s_waitcnt lgkmcnt(5)
    v_mfma_f32_16x16x32_bf16 v[168:171], a[208:211], a[72:75], 0
    s_mov_b32 m0, s95
    s_nop 0
    buffer_load_dwordx4 v230, s[8:11], 0 offen offset:0 nt lds
    s_waitcnt lgkmcnt(4)
    v_mfma_f32_16x16x32_bf16 v[168:171], a[212:215], a[76:79], v[168:171]
    s_waitcnt lgkmcnt(3)
    v_mfma_f32_16x16x32_bf16 v[168:171], a[216:219], a[80:83], v[168:171]
    s_waitcnt lgkmcnt(2)
    v_mfma_f32_16x16x32_bf16 v[168:171], a[220:223], a[84:87], v[168:171]
    s_waitcnt lgkmcnt(1)
    s_mov_b32 m0, s96
    s_nop 0
    buffer_load_dwordx4 v230, s[8:11], 0 offen offset:128 nt lds
    v_mfma_f32_16x16x32_bf16 v[168:171], a[224:227], a[88:91], v[168:171]
    s_waitcnt lgkmcnt(0)
    v_mfma_f32_16x16x32_bf16 v[168:171], a[228:231], a[92:95], v[168:171]
    v_mfma_f32_16x16x32_bf16 v[172:175], a[232:235], a[72:75], 0
    v_mfma_f32_16x16x32_bf16 v[172:175], a[236:239], a[76:79], v[172:175]
    v_mfma_f32_16x16x32_bf16 v[172:175], a[240:243], a[80:83], v[172:175]
    v_mfma_f32_16x16x32_bf16 v[172:175], a[244:247], a[84:87], v[172:175]
    s_mov_b32 m0, s97
    s_nop 0
    buffer_load_dwordx4 v230, s[8:11], 0 offen offset:256 nt lds
    v_mfma_f32_16x16x32_bf16 v[172:175], a[248:251], a[88:91], v[172:175]
    v_mfma_f32_16x16x32_bf16 v[172:175], a[252:255], a[92:95], v[172:175]
    v_mfma_f32_16x16x32_bf16 v[200:203], a[96:99], a[72:75], 0
    v_mfma_f32_16x16x32_bf16 v[200:203], a[100:103], a[76:79], v[200:203]
    v_mfma_f32_16x16x32_bf16 v[200:203], a[104:107], a[80:83], v[200:203]
    v_mfma_f32_16x16x32_bf16 v[200:203], a[108:111], a[84:87], v[200:203]
    v_mov_b32 v243, v239
    s_mov_b32 m0, s98
    s_nop 0
    buffer_load_dwordx4 v253, s[12:15], 0 offen offset:0 nt lds
    v_max3_f32 v235, v235, v168, v169
    v_mfma_f32_16x16x32_bf16 v[200:203], a[112:115], a[88:91], v[200:203]
    v_max3_f32 v235, v235, v170, v171
    v_max3_f32 v235, v235, v172, v173
    v_mfma_f32_16x16x32_bf16 v[200:203], a[116:119], a[92:95], v[200:203]
    v_max3_f32 v235, v235, v174, v175
    v_mov_b32 v239, v235
    s_mov_b32 m0, s99
    s_nop 0
    buffer_load_dwordx4 v253, s[12:15], 0 offen offset:128 nt lds
    v_mfma_f32_16x16x32_bf16 v[204:207], a[120:123], a[72:75], 0
    v_permlane32_swap_b32 v235, v239
    v_max_f32 v235, v235, v239
    v_mfma_f32_16x16x32_bf16 v[204:207], a[124:127], a[76:79], v[204:207]
    v_mov_b32 v239, v235
    s_nop 1
    v_permlane16_swap_b32 v235, v239
    v_mfma_f32_16x16x32_bf16 v[204:207], a[128:131], a[80:83], v[204:207]
    s_mov_b32 m0, s100
    s_nop 0
    buffer_load_dwordx4 v253, s[12:15], 0 offen offset:256 nt lds
    v_max_f32 v235, v235, v239
    v_mul_f32 v235, s29, v235
    v_mfma_f32_16x16x32_bf16 v[204:207], a[132:135], a[84:87], v[204:207]
    v_mov_b32 v239, 0
    v_fma_f32 v168, v168, s29, -v235
    v_mfma_f32_16x16x32_bf16 v[204:207], a[136:139], a[88:91], v[204:207]
    v_fma_f32 v169, v169, s29, -v235
    s_add_u32 m0, s35, 0
    s_nop 0
    buffer_load_dwordx4 v230, s[16:19], 0 offen offset:0 nt lds
    v_fma_f32 v170, v170, s29, -v235
    v_mfma_f32_16x16x32_bf16 v[204:207], a[140:143], a[92:95], v[204:207]
    v_fma_f32 v171, v171, s29, -v235
    v_fma_f32 v172, v172, s29, -v235
    v_fma_f32 v173, v173, s29, -v235
    v_fma_f32 v174, v174, s29, -v235
    v_fma_f32 v175, v175, s29, -v235
    s_add_u32 m0, s35, 896
    s_nop 0
    buffer_load_dwordx4 v230, s[16:19], 0 offen offset:128 nt lds
    v_exp_f32 v168, v168
    v_exp_f32 v169, v169
    v_exp_f32 v170, v170
    v_exp_f32 v171, v171
    v_exp_f32 v172, v172
    v_exp_f32 v173, v173
    v_exp_f32 v174, v174
    s_add_u32 m0, s35, 1792
    s_nop 0
    buffer_load_dwordx4 v230, s[16:19], 0 offen offset:256 nt lds
    v_exp_f32 v175, v175
    v_add_f32 v239, v239, v168
    v_cvt_pk_bf16_f32 v220, v168, v169
    v_cvt_pk_bf16_f32 v221, v170, v171
    v_add_f32 v239, v239, v169
    v_cvt_pk_bf16_f32 v222, v172, v173
    v_cvt_pk_bf16_f32 v223, v174, v175
    s_add_u32 m0, s35, 0
    s_nop 0
    buffer_load_dwordx4 v230, s[16:19], 0 offen offset:3072 nt lds
    v_add_f32 v239, v239, v170
    v_add_f32 v239, v239, v171
    v_add_f32 v239, v239, v172
    v_add_f32 v239, v239, v173
    v_add_f32 v239, v239, v174
    v_add_f32 v239, v239, v175
    s_waitcnt vmcnt(13)
    s_add_u32 m0, s35, 896
    s_nop 0
    buffer_load_dwordx4 v230, s[16:19], 0 offen offset:3200 nt lds
    s_barrier
    v_mfma_f32_16x16x32_bf16 v[132:135], v[220:223], a[144:147], 0
    ds_read_b128 a[96:99], v224 offset:0
    ds_read_b128 a[100:103], v225 offset:0
    v_mfma_f32_16x16x32_bf16 v[136:139], v[220:223], a[148:151], 0
    ds_read_b128 a[104:107], v224 offset:1024
    ds_read_b128 a[108:111], v225 offset:1024
    s_add_u32 m0, s35, 1792
    s_nop 0
    buffer_load_dwordx4 v230, s[16:19], 0 offen offset:3328 nt lds
    v_mfma_f32_16x16x32_bf16 v[140:143], v[220:223], a[152:155], 0
    ds_read_b128 a[112:115], v224 offset:2048
    ds_read_b128 a[116:119], v225 offset:2048
    v_mfma_f32_16x16x32_bf16 v[144:147], v[220:223], a[156:159], 0
    ds_read_b128 a[120:123], v224 offset:6144
    ds_read_b128 a[124:127], v225 offset:6144
    v_mfma_f32_16x16x32_bf16 v[148:151], v[220:223], a[160:163], 0
    ds_read_b128 a[128:131], v224 offset:7168
    ds_read_b128 a[132:135], v225 offset:7168
    v_mfma_f32_16x16x32_bf16 v[152:155], v[220:223], a[164:167], 0
    ds_read_b128 a[136:139], v224 offset:8192
    ds_read_b128 a[140:143], v225 offset:8192
    v_mfma_f32_16x16x32_bf16 v[156:159], v[220:223], a[168:171], 0
    v_fma_f32 v200, v200, s29, -v235
    v_fma_f32 v201, v201, s29, -v235
    v_mfma_f32_16x16x32_bf16 v[160:163], v[220:223], a[172:175], 0
    v_fma_f32 v202, v202, s29, -v235
    v_fma_f32 v203, v203, s29, -v235
    v_mfma_f32_16x16x32_bf16 v[164:167], v[220:223], a[176:179], 0
    v_fma_f32 v204, v204, s29, -v235
    v_fma_f32 v205, v205, s29, -v235
    v_mfma_f32_16x16x32_bf16 v[168:171], v[220:223], a[180:183], 0
    v_fma_f32 v206, v206, s29, -v235
    v_fma_f32 v207, v207, s29, -v235
    v_mfma_f32_16x16x32_bf16 v[172:175], v[220:223], a[184:187], 0
    v_mfma_f32_16x16x32_bf16 a[204:207], v[220:223], a[188:191], 0
    s_add_u32 s8, s8, 12288
    s_addc_u32 s9, s9, 0
    s_add_u32 s12, s12, 12288
    s_addc_u32 s13, s13, 0
    s_add_u32 s16, s16, 6144
    s_addc_u32 s17, s17, 0
    s_add_u32 s35, s35, 6144
    s_add_u32 s28, s28, 3072
    s_waitcnt vmcnt(12) lgkmcnt(0)
.p2align 3
.p2align 5
L_O:
    v_mfma_f32_16x16x32_bf16 v[176:179], a[96:99], a[0:3], 0
    s_barrier
    v_add_f32 v238, v238, v196
    v_add_f32 v238, v238, v197
    v_mfma_f32_16x16x32_bf16 v[176:179], a[100:103], a[4:7], v[176:179]
    ds_read_b64_tr_b16 a[144:145], v226 offset:36864
    ds_read_b64_tr_b16 a[146:147], v226 offset:43008
    v_mfma_f32_16x16x32_bf16 v[176:179], a[104:107], a[8:11], v[176:179]
    s_mov_b32 m0, s92
    v_exp_f32 v198, v198
    v_mfma_f32_16x16x32_bf16 v[176:179], a[108:111], a[12:15], v[176:179]
    buffer_load_dwordx4 v230, s[8:11], 0 offen offset:0 nt lds
    v_cvt_pk_bf16_f32 v218, v196, v197
    v_mfma_f32_16x16x32_bf16 v[176:179], a[112:115], a[16:19], v[176:179]
    ds_read_b64_tr_b16 a[148:149], v227 offset:36864
    v_add_f32 v238, v238, v198
    v_mfma_f32_16x16x32_bf16 v[176:179], a[116:119], a[20:23], v[176:179]
    v_exp_f32 v199, v199
    v_mfma_f32_16x16x32_bf16 v[180:183], a[120:123], a[0:3], 0
    ds_read_b64_tr_b16 a[150:151], v227 offset:43008
    v_add_f32 v238, v238, v199
    v_mfma_f32_16x16x32_bf16 v[180:183], a[124:127], a[4:7], v[180:183]
    ds_read_b64_tr_b16 a[152:153], v228 offset:36864
    v_cvt_pk_bf16_f32 v219, v198, v199
    v_mfma_f32_16x16x32_bf16 v[180:183], a[128:131], a[8:11], v[180:183]
    s_mov_b32 m0, s93
    v_exp_f32 v200, v200
    v_mfma_f32_16x16x32_bf16 v[180:183], a[132:135], a[12:15], v[180:183]
    buffer_load_dwordx4 v230, s[8:11], 0 offen offset:128 nt lds
    v_add_f32 v239, v239, v200
    v_mfma_f32_16x16x32_bf16 v[180:183], a[136:139], a[16:19], v[180:183]
    ds_read_b64_tr_b16 a[154:155], v228 offset:43008
    v_mfma_f32_16x16x32_bf16 v[180:183], a[140:143], a[20:23], v[180:183]
    v_exp_f32 v201, v201
    v_mfma_f32_16x16x32_bf16 v[184:187], a[96:99], a[24:27], 0
    ds_read_b64_tr_b16 a[156:157], v229 offset:36864
    v_add_f32 v239, v239, v201
    v_mfma_f32_16x16x32_bf16 v[184:187], a[100:103], a[28:31], v[184:187]
    ds_read_b64_tr_b16 a[158:159], v229 offset:43008
    v_cvt_pk_bf16_f32 v220, v200, v201
    v_mfma_f32_16x16x32_bf16 v[184:187], a[104:107], a[32:35], v[184:187]
    s_mov_b32 m0, s94
    v_exp_f32 v202, v202
    v_mfma_f32_16x16x32_bf16 v[184:187], a[108:111], a[36:39], v[184:187]
    buffer_load_dwordx4 v230, s[8:11], 0 offen offset:256 nt lds
    v_fma_f32 v176, v176, s29, -v232
    v_mfma_f32_16x16x32_bf16 v[184:187], a[112:115], a[40:43], v[184:187]
    ds_read_b64_tr_b16 a[160:161], v226 offset:37888
    ds_read_b64_tr_b16 a[162:163], v226 offset:44032
    v_mfma_f32_16x16x32_bf16 v[184:187], a[116:119], a[44:47], v[184:187]
    s_add_u32 s8, s8, 12288
    v_exp_f32 v203, v203
    v_mfma_f32_16x16x32_bf16 v[188:191], a[120:123], a[24:27], 0
    ds_read_b64_tr_b16 a[164:165], v227 offset:37888
    v_fma_f32 v177, v177, s29, -v232
    v_mfma_f32_16x16x32_bf16 v[188:191], a[124:127], a[28:31], v[188:191]
    ds_read_b64_tr_b16 a[166:167], v227 offset:44032
    v_add_f32 v239, v239, v202
    v_mfma_f32_16x16x32_bf16 v[188:191], a[128:131], a[32:35], v[188:191]
    s_addc_u32 s9, s9, 0
    v_exp_f32 v204, v204
    v_mfma_f32_16x16x32_bf16 v[188:191], a[132:135], a[36:39], v[188:191]
    buffer_load_dword v252, v254, s[84:87], 0 offen
    v_add_f32 v239, v239, v203
    v_mfma_f32_16x16x32_bf16 v[188:191], a[136:139], a[40:43], v[188:191]
    ds_read_b64_tr_b16 a[168:169], v228 offset:37888
    v_cvt_pk_bf16_f32 v221, v202, v203
    v_mfma_f32_16x16x32_bf16 v[188:191], a[140:143], a[44:47], v[188:191]
    v_exp_f32 v205, v205
    v_mfma_f32_16x16x32_bf16 v[192:195], a[96:99], a[48:51], 0
    ds_read_b64_tr_b16 a[170:171], v228 offset:44032
    v_add_f32 v239, v239, v204
    v_mfma_f32_16x16x32_bf16 v[192:195], a[100:103], a[52:55], v[192:195]
    ds_read_b64_tr_b16 a[172:173], v229 offset:37888
    v_add_f32 v239, v239, v205
    v_mfma_f32_16x16x32_bf16 v[192:195], a[104:107], a[56:59], v[192:195]
    v_exp_f32 v206, v206
    v_mfma_f32_16x16x32_bf16 v[192:195], a[108:111], a[60:63], v[192:195]
    ds_read_b64_tr_b16 a[174:175], v229 offset:44032
    v_cvt_pk_bf16_f32 v222, v204, v205
    v_mfma_f32_16x16x32_bf16 v[192:195], a[112:115], a[64:67], v[192:195]
    ds_read_b64_tr_b16 a[176:177], v226 offset:38912
    ds_read_b64_tr_b16 a[178:179], v226 offset:45056
    v_mfma_f32_16x16x32_bf16 v[192:195], a[116:119], a[68:71], v[192:195]
    s_add_u32 s84, s84, s0
    v_exp_f32 v207, v207
    v_mfma_f32_16x16x32_bf16 v[196:199], a[120:123], a[48:51], 0
    ds_read_b64_tr_b16 a[180:181], v227 offset:38912
    v_add_f32 v239, v239, v206
    v_mfma_f32_16x16x32_bf16 v[196:199], a[124:127], a[52:55], v[196:199]
    ds_read_b64_tr_b16 a[182:183], v227 offset:45056
    v_add_f32 v239, v239, v207
    v_mfma_f32_16x16x32_bf16 v[196:199], a[128:131], a[56:59], v[196:199]
    s_addc_u32 s85, s85, 0
    v_exp_f32 v176, v176
    v_mfma_f32_16x16x32_bf16 v[196:199], a[132:135], a[60:63], v[196:199]
    ds_read_b64_tr_b16 a[184:185], v228 offset:38912
    v_cvt_pk_bf16_f32 v223, v206, v207
    v_mfma_f32_16x16x32_bf16 v[196:199], a[136:139], a[64:67], v[196:199]
    ds_read_b64_tr_b16 a[186:187], v228 offset:45056
    v_fma_f32 v178, v178, s29, -v232
    v_mfma_f32_16x16x32_bf16 v[196:199], a[140:143], a[68:71], v[196:199]
    s_sub_u32 s1, s1, 1
    v_exp_f32 v177, v177
    v_mfma_f32_16x16x32_bf16 v[200:203], a[96:99], a[72:75], 0
    ds_read_b64_tr_b16 a[188:189], v229 offset:38912
    v_fma_f32 v179, v179, s29, -v232
    v_mfma_f32_16x16x32_bf16 v[200:203], a[100:103], a[76:79], v[200:203]
    ds_read_b64_tr_b16 a[190:191], v229 offset:45056
    v_fma_f32 v180, v180, s29, -v232
    v_mfma_f32_16x16x32_bf16 v[200:203], a[104:107], a[80:83], v[200:203]
    s_cselect_b32 s86, 0, s86
    v_exp_f32 v178, v178
    v_mfma_f32_16x16x32_bf16 v[200:203], a[108:111], a[84:87], v[200:203]
    v_fma_f32 v181, v181, s29, -v232
    v_fma_f32 v182, v182, s29, -v232
    v_mfma_f32_16x16x32_bf16 v[200:203], a[112:115], a[88:91], v[200:203]
    v_fma_f32 v183, v183, s29, -v232
    v_fma_f32 v184, v184, s29, -v233
    v_mfma_f32_16x16x32_bf16 v[200:203], a[116:119], a[92:95], v[200:203]
    v_exp_f32 v179, v179
    v_mfma_f32_16x16x32_bf16 v[204:207], a[120:123], a[72:75], 0
    v_fma_f32 v185, v185, s29, -v233
    v_fma_f32 v186, v186, s29, -v233
    v_mfma_f32_16x16x32_bf16 v[204:207], a[124:127], a[76:79], v[204:207]
    v_fma_f32 v187, v187, s29, -v233
    v_fma_f32 v188, v188, s29, -v233
    v_mfma_f32_16x16x32_bf16 v[204:207], a[128:131], a[80:83], v[204:207]
    v_exp_f32 v180, v180
    v_mfma_f32_16x16x32_bf16 v[204:207], a[132:135], a[84:87], v[204:207]
    v_fma_f32 v189, v189, s29, -v233
    v_fma_f32 v190, v190, s29, -v233
    v_mfma_f32_16x16x32_bf16 v[204:207], a[136:139], a[88:91], v[204:207]
    v_fma_f32 v191, v191, s29, -v233
    v_fma_f32 v192, v192, s29, -v234
    v_mfma_f32_16x16x32_bf16 v[204:207], a[140:143], a[92:95], v[204:207]
    s_waitcnt vmcnt(13) lgkmcnt(0)
    v_exp_f32 v181, v181
    v_mfma_f32_16x16x32_bf16 v[0:3], v[208:211], a[144:147], v[0:3]
    s_barrier
    v_fma_f32 v193, v193, s29, -v234
    v_fma_f32 v194, v194, s29, -v234
    v_mfma_f32_16x16x32_bf16 v[4:7], v[208:211], a[148:151], v[4:7]
    ds_read_b128 a[96:99], v224 offset:12288
    v_fma_f32 v195, v195, s29, -v234
    v_mfma_f32_16x16x32_bf16 v[8:11], v[208:211], a[152:155], v[8:11]
    s_mov_b32 m0, s101
    v_exp_f32 v182, v182
    v_mfma_f32_16x16x32_bf16 v[12:15], v[208:211], a[156:159], v[12:15]
    buffer_load_dwordx4 v253, s[12:15], 0 offen offset:0 nt lds
    v_fma_f32 v196, v196, s29, -v234
    v_mfma_f32_16x16x32_bf16 v[16:19], v[208:211], a[160:163], v[16:19]
    ds_read_b128 a[100:103], v225 offset:12288
    v_fma_f32 v197, v197, s29, -v234
    v_mfma_f32_16x16x32_bf16 v[20:23], v[208:211], a[164:167], v[20:23]
    v_exp_f32 v183, v183
    v_mfma_f32_16x16x32_bf16 v[24:27], v[208:211], a[168:171], v[24:27]
    ds_read_b128 a[104:107], v224 offset:13312
    v_add_f32 v236, v236, v176
    v_mfma_f32_16x16x32_bf16 v[28:31], v[208:211], a[172:175], v[28:31]
    ds_read_b128 a[108:111], v225 offset:13312
    v_add_f32 v236, v236, v177
    v_mfma_f32_16x16x32_bf16 v[32:35], v[208:211], a[176:179], v[32:35]
    s_mov_b32 m0, s37
    v_exp_f32 v184, v184
    v_mfma_f32_16x16x32_bf16 v[36:39], v[208:211], a[180:183], v[36:39]
    buffer_load_dwordx4 v253, s[12:15], 0 offen offset:128 nt lds
    v_add_f32 v236, v236, v178
    v_mfma_f32_16x16x32_bf16 v[40:43], v[208:211], a[184:187], v[40:43]
    ds_read_b128 a[112:115], v224 offset:14336
    v_add_f32 v236, v236, v179
    v_mfma_f32_16x16x32_bf16 a[192:195], v[208:211], a[188:191], a[192:195]
    v_exp_f32 v185, v185
    v_mfma_f32_16x16x32_bf16 v[44:47], v[212:215], a[144:147], v[44:47]
    v_cvt_pk_bf16_f32 v208, v176, v177
    v_cvt_pk_bf16_f32 v209, v178, v179
    v_mfma_f32_16x16x32_bf16 v[48:51], v[212:215], a[148:151], v[48:51]
    ds_read_b128 a[116:119], v225 offset:14336
    v_add_f32 v236, v236, v180
    v_mfma_f32_16x16x32_bf16 v[52:55], v[212:215], a[152:155], v[52:55]
    s_mov_b32 m0, s3
    v_exp_f32 v186, v186
    v_mfma_f32_16x16x32_bf16 v[56:59], v[212:215], a[156:159], v[56:59]
    buffer_load_dwordx4 v253, s[12:15], 0 offen offset:256 nt lds
    v_add_f32 v236, v236, v181
    v_mfma_f32_16x16x32_bf16 v[60:63], v[212:215], a[160:163], v[60:63]
    ds_read_b128 a[120:123], v224 offset:18432
    v_cvt_pk_bf16_f32 v210, v180, v181
    v_mfma_f32_16x16x32_bf16 v[64:67], v[212:215], a[164:167], v[64:67]
    s_add_u32 s12, s12, 12288
    v_exp_f32 v187, v187
    v_mfma_f32_16x16x32_bf16 v[68:71], v[212:215], a[168:171], v[68:71]
    ds_read_b128 a[124:127], v225 offset:18432
    v_add_f32 v236, v236, v182
    v_mfma_f32_16x16x32_bf16 v[72:75], v[212:215], a[172:175], v[72:75]
    ds_read_b128 a[128:131], v224 offset:19456
    v_add_f32 v236, v236, v183
    v_mfma_f32_16x16x32_bf16 v[76:79], v[212:215], a[176:179], v[76:79]
    s_addc_u32 s13, s13, 0
    v_exp_f32 v188, v188
    v_mfma_f32_16x16x32_bf16 v[80:83], v[212:215], a[180:183], v[80:83]
    s_cmp_eq_u32 s12, s26
    v_cvt_pk_bf16_f32 v211, v182, v183
    v_add_f32 v237, v237, v184
    v_mfma_f32_16x16x32_bf16 v[84:87], v[212:215], a[184:187], v[84:87]
    ds_read_b128 a[132:135], v225 offset:19456
    v_add_f32 v237, v237, v185
    v_mfma_f32_16x16x32_bf16 a[196:199], v[212:215], a[188:191], a[196:199]
    s_cselect_b64 s[12:13], s[90:91], s[12:13]
    v_exp_f32 v189, v189
    v_mfma_f32_16x16x32_bf16 v[88:91], v[216:219], a[144:147], v[88:91]
    ds_read_b128 a[136:139], v224 offset:20480
    v_cvt_pk_bf16_f32 v212, v184, v185
    v_mfma_f32_16x16x32_bf16 v[92:95], v[216:219], a[148:151], v[92:95]
    ds_read_b128 a[140:143], v225 offset:20480
    v_add_f32 v237, v237, v186
    v_mfma_f32_16x16x32_bf16 v[96:99], v[216:219], a[152:155], v[96:99]
    s_cselect_b32 s14, s27, s14
    v_exp_f32 v190, v190
    v_mfma_f32_16x16x32_bf16 v[100:103], v[216:219], a[156:159], v[100:103]
    ds_read_b64_tr_b16 a[208:209], v231 offset:0
    v_add_f32 v237, v237, v187
    v_mfma_f32_16x16x32_bf16 v[104:107], v[216:219], a[160:163], v[104:107]
    ds_read_b64_tr_b16 a[210:211], v231 offset:64
    v_cvt_pk_bf16_f32 v213, v186, v187
    v_mfma_f32_16x16x32_bf16 v[108:111], v[216:219], a[164:167], v[108:111]
    v_exp_f32 v191, v191
    v_mfma_f32_16x16x32_bf16 v[112:115], v[216:219], a[168:171], v[112:115]
    v_add_f32 v237, v237, v188
    v_add_f32 v237, v237, v189
    v_mfma_f32_16x16x32_bf16 v[116:119], v[216:219], a[172:175], v[116:119]
    ds_read_b64_tr_b16 a[212:213], v231 offset:1024
    v_cvt_pk_bf16_f32 v214, v188, v189
    v_mfma_f32_16x16x32_bf16 v[120:123], v[216:219], a[176:179], v[120:123]
    s_sub_u32 s30, s30, 1
    v_exp_f32 v192, v192
    v_mfma_f32_16x16x32_bf16 v[124:127], v[216:219], a[180:183], v[124:127]
    ds_read_b64_tr_b16 a[214:215], v231 offset:1088
    v_add_f32 v237, v237, v190
    v_mfma_f32_16x16x32_bf16 v[128:131], v[216:219], a[184:187], v[128:131]
    ds_read_b64_tr_b16 a[216:217], v231 offset:2048
    v_add_f32 v237, v237, v191
    v_mfma_f32_16x16x32_bf16 a[200:203], v[216:219], a[188:191], a[200:203]
    s_cmp_eq_u32 s30, 0
    v_exp_f32 v193, v193
    v_mfma_f32_16x16x32_bf16 v[132:135], v[220:223], a[144:147], v[132:135]
    ds_read_b64_tr_b16 a[218:219], v231 offset:2112
    v_cvt_pk_bf16_f32 v215, v190, v191
    v_mfma_f32_16x16x32_bf16 v[136:139], v[220:223], a[148:151], v[136:139]
    v_add_f32 v238, v238, v192
    v_add_f32 v238, v238, v193
    v_mfma_f32_16x16x32_bf16 v[140:143], v[220:223], a[152:155], v[140:143]
    v_exp_f32 v194, v194
    v_mfma_f32_16x16x32_bf16 v[144:147], v[220:223], a[156:159], v[144:147]
    v_cvt_pk_bf16_f32 v216, v192, v193
    v_add_f32 v238, v238, v194
    v_mfma_f32_16x16x32_bf16 v[148:151], v[220:223], a[160:163], v[148:151]
    v_fma_f32 v198, v198, s29, -v234
    v_fma_f32 v199, v199, s29, -v234
    v_mfma_f32_16x16x32_bf16 v[152:155], v[220:223], a[164:167], v[152:155]
    v_exp_f32 v195, v195
    v_mfma_f32_16x16x32_bf16 v[156:159], v[220:223], a[168:171], v[156:159]
    v_add_f32 v238, v238, v195
    v_cvt_pk_bf16_f32 v217, v194, v195
    v_mfma_f32_16x16x32_bf16 v[160:163], v[220:223], a[172:175], v[160:163]
    v_fma_f32 v200, v200, s29, -v235
    v_fma_f32 v201, v201, s29, -v235
    v_mfma_f32_16x16x32_bf16 v[164:167], v[220:223], a[176:179], v[164:167]
    v_exp_f32 v196, v196
    v_mfma_f32_16x16x32_bf16 v[168:171], v[220:223], a[180:183], v[168:171]
    v_fma_f32 v202, v202, s29, -v235
    v_fma_f32 v203, v203, s29, -v235
    v_mfma_f32_16x16x32_bf16 v[172:175], v[220:223], a[184:187], v[172:175]
    v_fma_f32 v204, v204, s29, -v235
    v_fma_f32 v205, v205, s29, -v235
    v_mfma_f32_16x16x32_bf16 a[204:207], v[220:223], a[188:191], a[204:207]
    s_waitcnt vmcnt(10) lgkmcnt(0)
    v_exp_f32 v197, v197
    v_fma_f32 v206, v206, s29, -v235
    v_fma_f32 v207, v207, s29, -v235
    s_cbranch_scc1 L_X
.p2align 3
    v_mfma_f32_16x16x32_bf16 v[176:179], a[96:99], a[0:3], 0
    s_barrier
    v_mfma_f32_16x16x32_bf16 v[176:179], a[100:103], a[4:7], v[176:179]
    ds_read_b64_tr_b16 a[144:145], v226 offset:24576
    ds_read_b64_tr_b16 a[146:147], v226 offset:30720
    v_mfma_f32_16x16x32_bf16 v[176:179], a[104:107], a[8:11], v[176:179]
    s_mov_b32 m0, s95
    v_exp_f32 v198, v198
    v_mfma_f32_16x16x32_bf16 v[176:179], a[108:111], a[12:15], v[176:179]
    buffer_load_dwordx4 v230, s[8:11], 0 offen offset:0 nt lds
    v_mfma_f32_16x16x32_bf16 v[176:179], a[112:115], a[16:19], v[176:179]
    ds_read_b64_tr_b16 a[148:149], v227 offset:24576
    v_add_f32 v238, v238, v196
    v_mfma_f32_16x16x32_bf16 v[176:179], a[116:119], a[20:23], v[176:179]
    v_exp_f32 v199, v199
    v_mfma_f32_16x16x32_bf16 v[180:183], a[120:123], a[0:3], 0
    ds_read_b64_tr_b16 a[150:151], v227 offset:30720
    v_add_f32 v238, v238, v197
    v_mfma_f32_16x16x32_bf16 v[180:183], a[124:127], a[4:7], v[180:183]
    ds_read_b64_tr_b16 a[152:153], v228 offset:24576
    v_cvt_pk_bf16_f32 v218, v196, v197
    v_mfma_f32_16x16x32_bf16 v[180:183], a[128:131], a[8:11], v[180:183]
    s_mov_b32 m0, s96
    v_exp_f32 v200, v200
    v_mfma_f32_16x16x32_bf16 v[180:183], a[132:135], a[12:15], v[180:183]
    buffer_load_dwordx4 v230, s[8:11], 0 offen offset:128 nt lds
    v_add_f32 v238, v238, v198
    v_mfma_f32_16x16x32_bf16 v[180:183], a[136:139], a[16:19], v[180:183]
    ds_read_b64_tr_b16 a[154:155], v228 offset:30720
    v_add_f32 v238, v238, v199
    v_mfma_f32_16x16x32_bf16 v[180:183], a[140:143], a[20:23], v[180:183]
    v_exp_f32 v201, v201
    v_mfma_f32_16x16x32_bf16 v[184:187], a[96:99], a[24:27], 0
    ds_read_b64_tr_b16 a[156:157], v229 offset:24576
    ds_read_b64_tr_b16 a[158:159], v229 offset:30720
    v_mfma_f32_16x16x32_bf16 v[184:187], a[100:103], a[28:31], v[184:187]
    ds_read_b64_tr_b16 a[160:161], v226 offset:25600
    v_cvt_pk_bf16_f32 v219, v198, v199
    v_mfma_f32_16x16x32_bf16 v[184:187], a[104:107], a[32:35], v[184:187]
    s_mov_b32 m0, s97
    v_exp_f32 v202, v202
    v_mfma_f32_16x16x32_bf16 v[184:187], a[108:111], a[36:39], v[184:187]
    buffer_load_dwordx4 v230, s[8:11], 0 offen offset:256 nt lds
    v_fma_f32 v176, v176, s29, -v232
    v_mfma_f32_16x16x32_bf16 v[184:187], a[112:115], a[40:43], v[184:187]
    ds_read_b64_tr_b16 a[162:163], v226 offset:31744
    v_fma_f32 v177, v177, s29, -v232
    v_mfma_f32_16x16x32_bf16 v[184:187], a[116:119], a[44:47], v[184:187]
    s_add_u32 s8, s8, 12288
    v_exp_f32 v203, v203
    v_mfma_f32_16x16x32_bf16 v[188:191], a[120:123], a[24:27], 0
    ds_read_b64_tr_b16 a[164:165], v227 offset:25600
    v_add_f32 v239, v239, v200
    v_mfma_f32_16x16x32_bf16 v[188:191], a[124:127], a[28:31], v[188:191]
    ds_read_b64_tr_b16 a[166:167], v227 offset:31744
    v_add_f32 v239, v239, v201
    v_mfma_f32_16x16x32_bf16 v[188:191], a[128:131], a[32:35], v[188:191]
    s_addc_u32 s9, s9, 0
    v_exp_f32 v204, v204
    v_mfma_f32_16x16x32_bf16 v[188:191], a[132:135], a[36:39], v[188:191]
    buffer_store_dwordx4 a[208:211], v247, s[20:23], s28 offen offset:0 sc1
    v_cvt_pk_bf16_f32 v220, v200, v201
    v_add_f32 v239, v239, v202
    v_add_f32 v239, v239, v203
    v_cvt_pk_bf16_f32 v221, v202, v203
    v_mfma_f32_16x16x32_bf16 v[188:191], a[136:139], a[40:43], v[188:191]
    ds_read_b64_tr_b16 a[168:169], v228 offset:25600
    ds_read_b64_tr_b16 a[170:171], v228 offset:31744
    v_mfma_f32_16x16x32_bf16 v[188:191], a[140:143], a[44:47], v[188:191]
    s_cmp_eq_u32 s8, s25
    v_exp_f32 v205, v205
    v_mfma_f32_16x16x32_bf16 v[192:195], a[96:99], a[48:51], 0
    ds_read_b64_tr_b16 a[172:173], v229 offset:25600
    v_add_f32 v239, v239, v204
    v_mfma_f32_16x16x32_bf16 v[192:195], a[100:103], a[52:55], v[192:195]
    ds_read_b64_tr_b16 a[174:175], v229 offset:31744
    v_add_f32 v239, v239, v205
    v_mfma_f32_16x16x32_bf16 v[192:195], a[104:107], a[56:59], v[192:195]
    s_cselect_b64 s[8:9], s[88:89], s[8:9]
    v_exp_f32 v206, v206
    v_mfma_f32_16x16x32_bf16 v[192:195], a[108:111], a[60:63], v[192:195]
    ds_read_b64_tr_b16 a[176:177], v226 offset:26624
    v_cvt_pk_bf16_f32 v222, v204, v205
    v_mfma_f32_16x16x32_bf16 v[192:195], a[112:115], a[64:67], v[192:195]
    ds_read_b64_tr_b16 a[178:179], v226 offset:32768
    v_add_f32 v239, v239, v206
    v_mfma_f32_16x16x32_bf16 v[192:195], a[116:119], a[68:71], v[192:195]
    s_cselect_b32 s10, s27, s10
    v_exp_f32 v207, v207
    v_mfma_f32_16x16x32_bf16 v[196:199], a[120:123], a[48:51], 0
    ds_read_b64_tr_b16 a[180:181], v227 offset:26624
    ds_read_b64_tr_b16 a[182:183], v227 offset:32768
    v_mfma_f32_16x16x32_bf16 v[196:199], a[124:127], a[52:55], v[196:199]
    ds_read_b64_tr_b16 a[184:185], v228 offset:26624
    v_add_f32 v239, v239, v207
    v_mfma_f32_16x16x32_bf16 v[196:199], a[128:131], a[56:59], v[196:199]
    v_exp_f32 v176, v176
    v_mfma_f32_16x16x32_bf16 v[196:199], a[132:135], a[60:63], v[196:199]
    buffer_store_dwordx4 a[212:215], v247, s[20:23], s28 offen offset:128 sc1
    v_cvt_pk_bf16_f32 v223, v206, v207
    v_fma_f32 v178, v178, s29, -v232
    v_fma_f32 v179, v179, s29, -v232
    v_fma_f32 v180, v180, s29, -v232
    v_mfma_f32_16x16x32_bf16 v[196:199], a[136:139], a[64:67], v[196:199]
    ds_read_b64_tr_b16 a[186:187], v228 offset:32768
    v_fma_f32 v181, v181, s29, -v232
    v_mfma_f32_16x16x32_bf16 v[196:199], a[140:143], a[68:71], v[196:199]
    v_exp_f32 v177, v177
    v_mfma_f32_16x16x32_bf16 v[200:203], a[96:99], a[72:75], 0
    ds_read_b64_tr_b16 a[188:189], v229 offset:26624
    v_fma_f32 v182, v182, s29, -v232
    v_mfma_f32_16x16x32_bf16 v[200:203], a[100:103], a[76:79], v[200:203]
    ds_read_b64_tr_b16 a[190:191], v229 offset:32768
    v_fma_f32 v183, v183, s29, -v232
    v_mfma_f32_16x16x32_bf16 v[200:203], a[104:107], a[80:83], v[200:203]
    v_exp_f32 v178, v178
    v_mfma_f32_16x16x32_bf16 v[200:203], a[108:111], a[84:87], v[200:203]
    v_fma_f32 v184, v184, s29, -v233
    v_fma_f32 v185, v185, s29, -v233
    v_mfma_f32_16x16x32_bf16 v[200:203], a[112:115], a[88:91], v[200:203]
    v_fma_f32 v186, v186, s29, -v233
    v_fma_f32 v187, v187, s29, -v233
    v_mfma_f32_16x16x32_bf16 v[200:203], a[116:119], a[92:95], v[200:203]
    v_exp_f32 v179, v179
    v_mfma_f32_16x16x32_bf16 v[204:207], a[120:123], a[72:75], 0
    v_fma_f32 v188, v188, s29, -v233
    v_fma_f32 v189, v189, s29, -v233
    v_mfma_f32_16x16x32_bf16 v[204:207], a[124:127], a[76:79], v[204:207]
    v_fma_f32 v190, v190, s29, -v233
    v_fma_f32 v191, v191, s29, -v233
    v_mfma_f32_16x16x32_bf16 v[204:207], a[128:131], a[80:83], v[204:207]
    v_exp_f32 v180, v180
    v_mfma_f32_16x16x32_bf16 v[204:207], a[132:135], a[84:87], v[204:207]
    buffer_store_dwordx4 a[216:219], v247, s[20:23], s28 offen offset:256 sc1
    v_fma_f32 v192, v192, s29, -v234
    v_fma_f32 v193, v193, s29, -v234
    v_fma_f32 v194, v194, s29, -v234
    v_fma_f32 v195, v195, s29, -v234
    v_mfma_f32_16x16x32_bf16 v[204:207], a[136:139], a[88:91], v[204:207]
    v_fma_f32 v196, v196, s29, -v234
    v_fma_f32 v197, v197, s29, -v234
    v_mfma_f32_16x16x32_bf16 v[204:207], a[140:143], a[92:95], v[204:207]
    s_waitcnt vmcnt(10) lgkmcnt(0)
    v_exp_f32 v181, v181
    v_mfma_f32_16x16x32_bf16 v[0:3], v[208:211], a[144:147], v[0:3]
    s_barrier
    v_mfma_f32_16x16x32_bf16 v[4:7], v[208:211], a[148:151], v[4:7]
    ds_read_b128 a[96:99], v224 offset:0
    v_add_f32 v236, v236, v176
    v_mfma_f32_16x16x32_bf16 v[8:11], v[208:211], a[152:155], v[8:11]
    s_mov_b32 m0, s98
    v_exp_f32 v182, v182
    v_mfma_f32_16x16x32_bf16 v[12:15], v[208:211], a[156:159], v[12:15]
    buffer_load_dwordx4 v253, s[12:15], 0 offen offset:0 nt lds
    v_add_f32 v236, v236, v177
    v_mfma_f32_16x16x32_bf16 v[16:19], v[208:211], a[160:163], v[16:19]
    ds_read_b128 a[100:103], v225 offset:0
    v_add_f32 v236, v236, v178
    v_mfma_f32_16x16x32_bf16 v[20:23], v[208:211], a[164:167], v[20:23]
    v_exp_f32 v183, v183
    v_mfma_f32_16x16x32_bf16 v[24:27], v[208:211], a[168:171], v[24:27]
    v_add_f32 v236, v236, v179
    v_add_f32 v236, v236, v180
    v_mfma_f32_16x16x32_bf16 v[28:31], v[208:211], a[172:175], v[28:31]
    ds_read_b128 a[104:107], v224 offset:1024
    v_add_f32 v236, v236, v181
    v_mfma_f32_16x16x32_bf16 v[32:35], v[208:211], a[176:179], v[32:35]
    s_mov_b32 m0, s99
    v_exp_f32 v184, v184
    v_mfma_f32_16x16x32_bf16 v[36:39], v[208:211], a[180:183], v[36:39]
    buffer_load_dwordx4 v253, s[12:15], 0 offen offset:128 nt lds
    v_add_f32 v236, v236, v182
    v_mfma_f32_16x16x32_bf16 v[40:43], v[208:211], a[184:187], v[40:43]
    ds_read_b128 a[108:111], v225 offset:1024
    v_add_f32 v236, v236, v183
    v_mfma_f32_16x16x32_bf16 a[192:195], v[208:211], a[188:191], a[192:195]
    v_exp_f32 v185, v185
    v_mfma_f32_16x16x32_bf16 v[44:47], v[212:215], a[144:147], v[44:47]
    v_cvt_pk_bf16_f32 v208, v176, v177
    v_cvt_pk_bf16_f32 v209, v178, v179
    v_mfma_f32_16x16x32_bf16 v[48:51], v[212:215], a[148:151], v[48:51]
    ds_read_b128 a[112:115], v224 offset:2048
    v_cvt_pk_bf16_f32 v210, v180, v181
    v_mfma_f32_16x16x32_bf16 v[52:55], v[212:215], a[152:155], v[52:55]
    s_mov_b32 m0, s100
    v_exp_f32 v186, v186
    v_mfma_f32_16x16x32_bf16 v[56:59], v[212:215], a[156:159], v[56:59]
    buffer_load_dwordx4 v253, s[12:15], 0 offen offset:256 nt lds
    v_cvt_pk_bf16_f32 v211, v182, v183
    v_mfma_f32_16x16x32_bf16 v[60:63], v[212:215], a[160:163], v[60:63]
    ds_read_b128 a[116:119], v225 offset:2048
    v_add_f32 v237, v237, v184
    v_mfma_f32_16x16x32_bf16 v[64:67], v[212:215], a[164:167], v[64:67]
    v_exp_f32 v187, v187
    v_mfma_f32_16x16x32_bf16 v[68:71], v[212:215], a[168:171], v[68:71]
    v_add_f32 v237, v237, v185
    v_add_f32 v237, v237, v186
    v_mfma_f32_16x16x32_bf16 v[72:75], v[212:215], a[172:175], v[72:75]
    ds_read_b128 a[120:123], v224 offset:6144
    v_add_f32 v237, v237, v187
    v_mfma_f32_16x16x32_bf16 v[76:79], v[212:215], a[176:179], v[76:79]
    s_add_u32 m0, s35, 0
    v_exp_f32 v188, v188
    v_mfma_f32_16x16x32_bf16 v[80:83], v[212:215], a[180:183], v[80:83]
    buffer_load_dwordx4 v230, s[16:19], 0 offen offset:0 nt lds
    v_add_f32 v237, v237, v188
    v_mfma_f32_16x16x32_bf16 v[84:87], v[212:215], a[184:187], v[84:87]
    ds_read_b128 a[124:127], v225 offset:6144
    v_fma_f32 v198, v198, s29, -v234
    v_mfma_f32_16x16x32_bf16 a[196:199], v[212:215], a[188:191], a[196:199]
    s_add_u32 s12, s12, 12288
    v_exp_f32 v189, v189
    v_mfma_f32_16x16x32_bf16 v[88:91], v[216:219], a[144:147], v[88:91]
    s_addc_u32 s13, s13, 0
    v_cvt_pk_bf16_f32 v212, v184, v185
    v_cvt_pk_bf16_f32 v213, v186, v187
    v_mfma_f32_16x16x32_bf16 v[92:95], v[216:219], a[148:151], v[92:95]
    ds_read_b128 a[128:131], v224 offset:7168
    v_add_f32 v237, v237, v189
    v_mfma_f32_16x16x32_bf16 v[96:99], v[216:219], a[152:155], v[96:99]
    s_add_u32 m0, s35, 896
    v_exp_f32 v190, v190
    v_mfma_f32_16x16x32_bf16 v[100:103], v[216:219], a[156:159], v[100:103]
    buffer_load_dwordx4 v230, s[16:19], 0 offen offset:128 nt lds
    v_cvt_pk_bf16_f32 v214, v188, v189
    v_mfma_f32_16x16x32_bf16 v[104:107], v[216:219], a[160:163], v[104:107]
    ds_read_b128 a[132:135], v225 offset:7168
    v_add_f32 v237, v237, v190
    v_mfma_f32_16x16x32_bf16 v[108:111], v[216:219], a[164:167], v[108:111]
    v_exp_f32 v191, v191
    v_mfma_f32_16x16x32_bf16 v[112:115], v[216:219], a[168:171], v[112:115]
    v_add_f32 v237, v237, v191
    v_cvt_pk_bf16_f32 v215, v190, v191
    v_mfma_f32_16x16x32_bf16 v[116:119], v[216:219], a[172:175], v[116:119]
    ds_read_b128 a[136:139], v224 offset:8192
    v_fma_f32 v199, v199, s29, -v234
    v_mfma_f32_16x16x32_bf16 v[120:123], v[216:219], a[176:179], v[120:123]
    s_add_u32 m0, s35, 1792
    v_exp_f32 v192, v192
    v_mfma_f32_16x16x32_bf16 v[124:127], v[216:219], a[180:183], v[124:127]
    buffer_load_dwordx4 v230, s[16:19], 0 offen offset:256 nt lds
    v_add_f32 v238, v238, v192
    v_mfma_f32_16x16x32_bf16 v[128:131], v[216:219], a[184:187], v[128:131]
    ds_read_b128 a[140:143], v225 offset:8192
    v_fma_f32 v200, v200, s29, -v235
    v_mfma_f32_16x16x32_bf16 a[200:203], v[216:219], a[188:191], a[200:203]
    s_add_u32 s16, s16, 3072
    v_exp_f32 v193, v193
    v_mfma_f32_16x16x32_bf16 v[132:135], v[220:223], a[144:147], v[132:135]
    s_addc_u32 s17, s17, 0
    v_add_f32 v238, v238, v193
    v_cvt_pk_bf16_f32 v216, v192, v193
    v_mfma_f32_16x16x32_bf16 v[136:139], v[220:223], a[148:151], v[136:139]
    s_add_u32 s35, s35, 3072
    v_fma_f32 v201, v201, s29, -v235
    v_fma_f32 v202, v202, s29, -v235
    v_mfma_f32_16x16x32_bf16 v[140:143], v[220:223], a[152:155], v[140:143]
    s_add_u32 s28, s28, 3072
    v_exp_f32 v194, v194
    v_mfma_f32_16x16x32_bf16 v[144:147], v[220:223], a[156:159], v[144:147]
    v_add_f32 v238, v238, v194
    v_fma_f32 v203, v203, s29, -v235
    v_mfma_f32_16x16x32_bf16 v[148:151], v[220:223], a[160:163], v[148:151]
    v_fma_f32 v204, v204, s29, -v235
    v_fma_f32 v205, v205, s29, -v235
    v_mfma_f32_16x16x32_bf16 v[152:155], v[220:223], a[164:167], v[152:155]
    v_exp_f32 v195, v195
    v_mfma_f32_16x16x32_bf16 v[156:159], v[220:223], a[168:171], v[156:159]
    v_add_f32 v238, v238, v195
    v_cvt_pk_bf16_f32 v217, v194, v195
    v_mfma_f32_16x16x32_bf16 v[160:163], v[220:223], a[172:175], v[160:163]
    v_fma_f32 v206, v206, s29, -v235
    v_fma_f32 v207, v207, s29, -v235
    v_mfma_f32_16x16x32_bf16 v[164:167], v[220:223], a[176:179], v[164:167]
    v_exp_f32 v196, v196
    v_mfma_f32_16x16x32_bf16 v[168:171], v[220:223], a[180:183], v[168:171]
    v_add_u32 v231, 3072, v231
    v_mfma_f32_16x16x32_bf16 v[172:175], v[220:223], a[184:187], v[172:175]
    v_mfma_f32_16x16x32_bf16 a[204:207], v[220:223], a[188:191], a[204:207]
    s_waitcnt vmcnt(12) lgkmcnt(0)
    v_exp_f32 v197, v197
    s_branch L_O
.p2align 6
L_X:
    s_cmp_eq_u32 s31, 1
    s_cbranch_scc1 L_T
    v_mfma_f32_16x16x32_bf16 v[176:179], a[96:99], a[0:3], 0
    s_barrier
    v_mfma_f32_16x16x32_bf16 v[176:179], a[100:103], a[4:7], v[176:179]
    ds_read_b64_tr_b16 a[144:145], v226 offset:24576
    ds_read_b64_tr_b16 a[146:147], v226 offset:30720
    v_mfma_f32_16x16x32_bf16 v[176:179], a[104:107], a[8:11], v[176:179]
    s_mov_b32 m0, s95
    v_exp_f32 v198, v198
    v_mfma_f32_16x16x32_bf16 v[176:179], a[108:111], a[12:15], v[176:179]
    buffer_load_dwordx4 v230, s[8:11], 0 offen offset:0 nt lds
    v_mfma_f32_16x16x32_bf16 v[176:179], a[112:115], a[16:19], v[176:179]
    ds_read_b64_tr_b16 a[148:149], v227 offset:24576
    v_add_f32 v238, v238, v196
    v_mfma_f32_16x16x32_bf16 v[176:179], a[116:119], a[20:23], v[176:179]
    s_add_u32 s42, s32, 32
    v_exp_f32 v199, v199
    v_mfma_f32_16x16x32_bf16 v[180:183], a[120:123], a[0:3], 0
    ds_read_b64_tr_b16 a[150:151], v227 offset:30720
    v_add_f32 v238, v238, v197
    v_mfma_f32_16x16x32_bf16 v[180:183], a[124:127], a[4:7], v[180:183]
    ds_read_b64_tr_b16 a[152:153], v228 offset:24576
    v_cvt_pk_bf16_f32 v218, v196, v197
    v_mfma_f32_16x16x32_bf16 v[180:183], a[128:131], a[8:11], v[180:183]
    s_mov_b32 m0, s96
    v_exp_f32 v200, v200
    v_mfma_f32_16x16x32_bf16 v[180:183], a[132:135], a[12:15], v[180:183]
    buffer_load_dwordx4 v230, s[8:11], 0 offen offset:128 nt lds
    v_add_f32 v238, v238, v198
    v_mfma_f32_16x16x32_bf16 v[180:183], a[136:139], a[16:19], v[180:183]
    ds_read_b64_tr_b16 a[154:155], v228 offset:30720
    v_add_f32 v238, v238, v199
    v_mfma_f32_16x16x32_bf16 v[180:183], a[140:143], a[20:23], v[180:183]
    s_mul_hi_u32 s43, s42, 0x55555556
    v_exp_f32 v201, v201
    v_mfma_f32_16x16x32_bf16 v[184:187], a[96:99], a[24:27], 0
    ds_read_b64_tr_b16 a[156:157], v229 offset:24576
    ds_read_b64_tr_b16 a[158:159], v229 offset:30720
    v_mfma_f32_16x16x32_bf16 v[184:187], a[100:103], a[28:31], v[184:187]
    ds_read_b64_tr_b16 a[160:161], v226 offset:25600
    v_cvt_pk_bf16_f32 v219, v198, v199
    v_mfma_f32_16x16x32_bf16 v[184:187], a[104:107], a[32:35], v[184:187]
    s_mov_b32 m0, s97
    v_exp_f32 v202, v202
    v_mfma_f32_16x16x32_bf16 v[184:187], a[108:111], a[36:39], v[184:187]
    buffer_load_dwordx4 v230, s[8:11], 0 offen offset:256 nt lds
    v_fma_f32 v176, v176, s29, -v232
    v_mfma_f32_16x16x32_bf16 v[184:187], a[112:115], a[40:43], v[184:187]
    ds_read_b64_tr_b16 a[162:163], v226 offset:31744
    v_fma_f32 v177, v177, s29, -v232
    v_mfma_f32_16x16x32_bf16 v[184:187], a[116:119], a[44:47], v[184:187]
    s_mul_i32 s44, s43, 3
    v_exp_f32 v203, v203
    v_mfma_f32_16x16x32_bf16 v[188:191], a[120:123], a[24:27], 0
    ds_read_b64_tr_b16 a[164:165], v227 offset:25600
    v_add_f32 v239, v239, v200
    v_mfma_f32_16x16x32_bf16 v[188:191], a[124:127], a[28:31], v[188:191]
    ds_read_b64_tr_b16 a[166:167], v227 offset:31744
    v_add_f32 v239, v239, v201
    v_mfma_f32_16x16x32_bf16 v[188:191], a[128:131], a[32:35], v[188:191]
    s_sub_u32 s40, s42, s44
    v_exp_f32 v204, v204
    v_mfma_f32_16x16x32_bf16 v[188:191], a[132:135], a[36:39], v[188:191]
    buffer_store_dwordx4 a[208:211], v247, s[20:23], s28 offen offset:0 sc1
    v_cvt_pk_bf16_f32 v220, v200, v201
    v_add_f32 v239, v239, v202
    v_add_f32 v239, v239, v203
    v_cvt_pk_bf16_f32 v221, v202, v203
    v_mfma_f32_16x16x32_bf16 v[188:191], a[136:139], a[40:43], v[188:191]
    ds_read_b64_tr_b16 a[168:169], v228 offset:25600
    ds_read_b64_tr_b16 a[170:171], v228 offset:31744
    v_mfma_f32_16x16x32_bf16 v[188:191], a[140:143], a[44:47], v[188:191]
    s_mul_i32 s43, s43, 196608
    v_exp_f32 v205, v205
    v_mfma_f32_16x16x32_bf16 v[192:195], a[96:99], a[48:51], 0
    ds_read_b64_tr_b16 a[172:173], v229 offset:25600
    v_add_f32 v239, v239, v204
    v_mfma_f32_16x16x32_bf16 v[192:195], a[100:103], a[52:55], v[192:195]
    ds_read_b64_tr_b16 a[174:175], v229 offset:31744
    v_add_f32 v239, v239, v205
    v_mfma_f32_16x16x32_bf16 v[192:195], a[104:107], a[56:59], v[192:195]
    s_lshl_b32 s44, s31, 8
    v_exp_f32 v206, v206
    v_mfma_f32_16x16x32_bf16 v[192:195], a[108:111], a[60:63], v[192:195]
    ds_read_b64_tr_b16 a[176:177], v226 offset:26624
    v_cvt_pk_bf16_f32 v222, v204, v205
    v_mfma_f32_16x16x32_bf16 v[192:195], a[112:115], a[64:67], v[192:195]
    ds_read_b64_tr_b16 a[178:179], v226 offset:32768
    v_add_f32 v239, v239, v206
    v_mfma_f32_16x16x32_bf16 v[192:195], a[116:119], a[68:71], v[192:195]
    s_add_u32 s44, s44, s2
    v_exp_f32 v207, v207
    v_mfma_f32_16x16x32_bf16 v[196:199], a[120:123], a[48:51], 0
    ds_read_b64_tr_b16 a[180:181], v227 offset:26624
    ds_read_b64_tr_b16 a[182:183], v227 offset:32768
    v_mfma_f32_16x16x32_bf16 v[196:199], a[124:127], a[52:55], v[196:199]
    ds_read_b64_tr_b16 a[184:185], v228 offset:26624
    v_add_f32 v239, v239, v207
    v_mfma_f32_16x16x32_bf16 v[196:199], a[128:131], a[56:59], v[196:199]
    s_cmp_lt_u32 s44, 528
    v_exp_f32 v176, v176
    v_mfma_f32_16x16x32_bf16 v[196:199], a[132:135], a[60:63], v[196:199]
    buffer_store_dwordx4 a[212:215], v247, s[20:23], s28 offen offset:128 sc1
    v_cvt_pk_bf16_f32 v223, v206, v207
    v_fma_f32 v178, v178, s29, -v232
    v_fma_f32 v179, v179, s29, -v232
    v_fma_f32 v180, v180, s29, -v232
    v_mfma_f32_16x16x32_bf16 v[196:199], a[136:139], a[64:67], v[196:199]
    ds_read_b64_tr_b16 a[186:187], v228 offset:32768
    v_fma_f32 v181, v181, s29, -v232
    v_mfma_f32_16x16x32_bf16 v[196:199], a[140:143], a[68:71], v[196:199]
    s_cselect_b32 s44, 3, 2
    v_exp_f32 v177, v177
    v_mfma_f32_16x16x32_bf16 v[200:203], a[96:99], a[72:75], 0
    ds_read_b64_tr_b16 a[188:189], v229 offset:26624
    v_fma_f32 v182, v182, s29, -v232
    v_mfma_f32_16x16x32_bf16 v[200:203], a[100:103], a[76:79], v[200:203]
    ds_read_b64_tr_b16 a[190:191], v229 offset:32768
    v_fma_f32 v183, v183, s29, -v232
    v_mfma_f32_16x16x32_bf16 v[200:203], a[104:107], a[80:83], v[200:203]
    s_subb_u32 s40, s40, 0
    v_exp_f32 v178, v178
    v_mfma_f32_16x16x32_bf16 v[200:203], a[108:111], a[84:87], v[200:203]
    s_mul_i32 s44, s44, 2048
    v_fma_f32 v184, v184, s29, -v233
    v_fma_f32 v185, v185, s29, -v233
    v_mfma_f32_16x16x32_bf16 v[200:203], a[112:115], a[88:91], v[200:203]
    s_lshl_b32 s40, s40, 1
    v_fma_f32 v186, v186, s29, -v233
    v_fma_f32 v187, v187, s29, -v233
    v_mfma_f32_16x16x32_bf16 v[200:203], a[116:119], a[92:95], v[200:203]
    s_bitcmp1_b32 s24, 0
    v_exp_f32 v179, v179
    v_mfma_f32_16x16x32_bf16 v[204:207], a[120:123], a[72:75], 0
    s_addc_u32 s40, s40, 0
    v_fma_f32 v188, v188, s29, -v233
    v_fma_f32 v189, v189, s29, -v233
    v_mfma_f32_16x16x32_bf16 v[204:207], a[124:127], a[76:79], v[204:207]
    s_mul_i32 s40, s40, s44
    v_fma_f32 v190, v190, s29, -v233
    v_fma_f32 v191, v191, s29, -v233
    v_mfma_f32_16x16x32_bf16 v[204:207], a[128:131], a[80:83], v[204:207]
    s_add_u32 s43, s43, s40
    v_exp_f32 v180, v180
    v_mfma_f32_16x16x32_bf16 v[204:207], a[132:135], a[84:87], v[204:207]
    buffer_store_dwordx4 a[216:219], v247, s[20:23], s28 offen offset:256 sc1
    v_fma_f32 v192, v192, s29, -v234
    v_fma_f32 v193, v193, s29, -v234
    v_fma_f32 v194, v194, s29, -v234
    v_fma_f32 v195, v195, s29, -v234
    v_mfma_f32_16x16x32_bf16 v[204:207], a[136:139], a[88:91], v[204:207]
    s_add_u32 s43, s43, 172032
    s_cmp_lt_u32 s24, 2
    s_cselect_b64 s[84:85], s[6:7], s[54:55]
    s_add_u32 s84, s84, s43
    s_addc_u32 s85, s85, 0
    s_mov_b32 s86, s44
    s_add_u32 s8, s8, 12288
    s_addc_u32 s9, s9, 0
    v_mfma_f32_16x16x32_bf16 v[204:207], a[140:143], a[92:95], v[204:207]
    s_waitcnt vmcnt(10) lgkmcnt(0)
    v_exp_f32 v181, v181
    v_mfma_f32_16x16x32_bf16 v[0:3], v[208:211], a[144:147], v[0:3]
    s_barrier
    v_mfma_f32_16x16x32_bf16 v[4:7], v[208:211], a[148:151], v[4:7]
    ds_read_b128 a[96:99], v224 offset:0
    ds_read_b128 a[100:103], v225 offset:0
    v_mfma_f32_16x16x32_bf16 v[8:11], v[208:211], a[152:155], v[8:11]
    s_mov_b32 m0, s98
    v_exp_f32 v182, v182
    v_mfma_f32_16x16x32_bf16 v[12:15], v[208:211], a[156:159], v[12:15]
    buffer_load_dwordx4 v253, s[12:15], 0 offen offset:0 nt lds
    v_fma_f32 v196, v196, s29, -v234
    v_mfma_f32_16x16x32_bf16 v[16:19], v[208:211], a[160:163], v[16:19]
    ds_read_b128 a[104:107], v224 offset:1024
    ds_read_b128 a[108:111], v225 offset:1024
    v_mfma_f32_16x16x32_bf16 v[20:23], v[208:211], a[164:167], v[20:23]
    s_mul_i32 s39, s32, 98304
    v_exp_f32 v183, v183
    v_mfma_f32_16x16x32_bf16 v[24:27], v[208:211], a[168:171], v[24:27]
    ds_read_b128 a[112:115], v224 offset:2048
    v_fma_f32 v197, v197, s29, -v234
    v_mfma_f32_16x16x32_bf16 v[28:31], v[208:211], a[172:175], v[28:31]
    ds_read_b128 a[116:119], v225 offset:2048
    ds_read_b128 a[120:123], v224 offset:6144
    v_mfma_f32_16x16x32_bf16 v[32:35], v[208:211], a[176:179], v[32:35]
    s_mov_b32 m0, s99
    v_exp_f32 v184, v184
    v_mfma_f32_16x16x32_bf16 v[36:39], v[208:211], a[180:183], v[36:39]
    buffer_load_dwordx4 v253, s[12:15], 0 offen offset:128 nt lds
    v_add_f32 v236, v236, v176
    v_mfma_f32_16x16x32_bf16 v[40:43], v[208:211], a[184:187], v[40:43]
    ds_read_b128 a[124:127], v225 offset:6144
    ds_read_b128 a[128:131], v224 offset:7168
    v_mfma_f32_16x16x32_bf16 a[192:195], v[208:211], a[188:191], a[192:195]
    s_mul_i32 s40, s24, 24576
    v_exp_f32 v185, v185
    v_mfma_f32_16x16x32_bf16 v[44:47], v[212:215], a[144:147], v[44:47]
    ds_read_b128 a[132:135], v225 offset:7168
    v_add_f32 v236, v236, v177
    v_mfma_f32_16x16x32_bf16 v[48:51], v[212:215], a[148:151], v[48:51]
    ds_read_b128 a[136:139], v224 offset:8192
    ds_read_b128 a[140:143], v225 offset:8192
    v_mfma_f32_16x16x32_bf16 v[52:55], v[212:215], a[152:155], v[52:55]
    s_mov_b32 m0, s100
    v_exp_f32 v186, v186
    v_mfma_f32_16x16x32_bf16 v[56:59], v[212:215], a[156:159], v[56:59]
    buffer_load_dwordx4 v253, s[12:15], 0 offen offset:256 nt lds
    v_cvt_pk_bf16_f32 v208, v176, v177
    v_mfma_f32_16x16x32_bf16 v[60:63], v[212:215], a[160:163], v[60:63]
    ds_read_b128 a[0:3], v244 offset:0
    ds_read_b128 a[4:7], v245 offset:0
    v_mfma_f32_16x16x32_bf16 v[64:67], v[212:215], a[164:167], v[64:67]
    s_add_u32 s39, s39, s40
    v_exp_f32 v187, v187
    v_mfma_f32_16x16x32_bf16 v[68:71], v[212:215], a[168:171], v[68:71]
    ds_read_b128 a[8:11], v244 offset:1024
    v_add_f32 v236, v236, v178
    v_mfma_f32_16x16x32_bf16 v[72:75], v[212:215], a[172:175], v[72:75]
    ds_read_b128 a[12:15], v245 offset:1024
    ds_read_b128 a[16:19], v244 offset:2048
    v_mfma_f32_16x16x32_bf16 v[76:79], v[212:215], a[176:179], v[76:79]
    s_add_u32 s20, s48, s39
    v_exp_f32 v188, v188
    v_mfma_f32_16x16x32_bf16 v[80:83], v[212:215], a[180:183], v[80:83]
    ds_read_b128 a[20:23], v245 offset:2048
    v_add_f32 v236, v236, v179
    v_mfma_f32_16x16x32_bf16 v[84:87], v[212:215], a[184:187], v[84:87]
    ds_read_b128 a[24:27], v244 offset:6144
    ds_read_b128 a[28:31], v245 offset:6144
    s_addc_u32 s21, s49, 0
    s_mov_b32 s22, 24576
    v_mfma_f32_16x16x32_bf16 a[196:199], v[212:215], a[188:191], a[196:199]
    s_add_u32 s12, s12, 12288
    v_exp_f32 v189, v189
    v_mfma_f32_16x16x32_bf16 v[88:91], v[216:219], a[144:147], v[88:91]
    ds_read_b128 a[32:35], v244 offset:7168
    ds_read_b128 a[36:39], v245 offset:7168
    v_mfma_f32_16x16x32_bf16 v[92:95], v[216:219], a[148:151], v[92:95]
    ds_read_b128 a[40:43], v244 offset:8192
    v_cvt_pk_bf16_f32 v209, v178, v179
    v_mfma_f32_16x16x32_bf16 v[96:99], v[216:219], a[152:155], v[96:99]
    s_addc_u32 s13, s13, 0
    v_exp_f32 v190, v190
    v_mfma_f32_16x16x32_bf16 v[100:103], v[216:219], a[156:159], v[100:103]
    ds_read_b128 a[44:47], v245 offset:8192
    ds_read_b128 a[48:51], v244 offset:12288
    v_mfma_f32_16x16x32_bf16 v[104:107], v[216:219], a[160:163], v[104:107]
    ds_read_b128 a[52:55], v245 offset:12288
    ds_read_b128 a[56:59], v244 offset:13312
    v_mfma_f32_16x16x32_bf16 v[108:111], v[216:219], a[164:167], v[108:111]
    v_exp_f32 v191, v191
    v_mfma_f32_16x16x32_bf16 v[112:115], v[216:219], a[168:171], v[112:115]
    ds_read_b128 a[60:63], v245 offset:13312
    v_add_f32 v236, v236, v180
    v_mfma_f32_16x16x32_bf16 v[116:119], v[216:219], a[172:175], v[116:119]
    ds_read_b128 a[64:67], v244 offset:14336
    ds_read_b128 a[68:71], v245 offset:14336
    v_mfma_f32_16x16x32_bf16 v[120:123], v[216:219], a[176:179], v[120:123]
    v_exp_f32 v192, v192
    v_mfma_f32_16x16x32_bf16 v[124:127], v[216:219], a[180:183], v[124:127]
    ds_read_b128 a[72:75], v244 offset:18432
    ds_read_b128 a[76:79], v245 offset:18432
    v_mfma_f32_16x16x32_bf16 v[128:131], v[216:219], a[184:187], v[128:131]
    ds_read_b128 a[80:83], v244 offset:19456
    v_add_f32 v236, v236, v181
    v_mfma_f32_16x16x32_bf16 a[200:203], v[216:219], a[188:191], a[200:203]
    v_exp_f32 v193, v193
    v_mfma_f32_16x16x32_bf16 v[132:135], v[220:223], a[144:147], v[132:135]
    ds_read_b128 a[84:87], v245 offset:19456
    ds_read_b128 a[88:91], v244 offset:20480
    v_mfma_f32_16x16x32_bf16 v[136:139], v[220:223], a[148:151], v[136:139]
    ds_read_b128 a[92:95], v245 offset:20480
    v_cvt_pk_bf16_f32 v210, v180, v181
    v_mfma_f32_16x16x32_bf16 v[140:143], v[220:223], a[152:155], v[140:143]
    v_exp_f32 v194, v194
    v_mfma_f32_16x16x32_bf16 v[144:147], v[220:223], a[156:159], v[144:147]
    v_add_f32 v236, v236, v182
    v_add_f32 v236, v236, v183
    v_mfma_f32_16x16x32_bf16 v[148:151], v[220:223], a[160:163], v[148:151]
    v_cvt_pk_bf16_f32 v211, v182, v183
    v_add_f32 v237, v237, v184
    v_mfma_f32_16x16x32_bf16 v[152:155], v[220:223], a[164:167], v[152:155]
    v_exp_f32 v195, v195
    v_mfma_f32_16x16x32_bf16 v[156:159], v[220:223], a[168:171], v[156:159]
    v_add_f32 v237, v237, v185
    v_cvt_pk_bf16_f32 v212, v184, v185
    v_mfma_f32_16x16x32_bf16 v[160:163], v[220:223], a[172:175], v[160:163]
    v_add_f32 v237, v237, v186
    v_add_f32 v237, v237, v187
    v_mfma_f32_16x16x32_bf16 v[164:167], v[220:223], a[176:179], v[164:167]
    v_exp_f32 v196, v196
    v_mfma_f32_16x16x32_bf16 v[168:171], v[220:223], a[180:183], v[168:171]
    v_cvt_pk_bf16_f32 v213, v186, v187
    v_add_f32 v237, v237, v188
    v_mfma_f32_16x16x32_bf16 v[172:175], v[220:223], a[184:187], v[172:175]
    v_add_f32 v237, v237, v189
    v_cvt_pk_bf16_f32 v214, v188, v189
    v_mfma_f32_16x16x32_bf16 a[204:207], v[220:223], a[188:191], a[204:207]
    s_waitcnt vmcnt(9) lgkmcnt(0)
    v_exp_f32 v197, v197
    v_add_f32 v237, v237, v190
    v_add_f32 v237, v237, v191
    v_cvt_pk_bf16_f32 v215, v190, v191
    v_add_f32 v238, v238, v192
    v_add_f32 v238, v238, v193
    v_cvt_pk_bf16_f32 v216, v192, v193
    v_add_f32 v238, v238, v194
    v_add_f32 v238, v238, v195
    v_cvt_pk_bf16_f32 v217, v194, v195
    v_fma_f32 v198, v198, s29, -v234
    v_fma_f32 v199, v199, s29, -v234
    v_fma_f32 v200, v200, s29, -v235
    v_fma_f32 v201, v201, s29, -v235
    v_fma_f32 v202, v202, s29, -v235
    v_fma_f32 v203, v203, s29, -v235
    v_fma_f32 v204, v204, s29, -v235
    v_fma_f32 v205, v205, s29, -v235
    v_fma_f32 v206, v206, s29, -v235
    v_fma_f32 v207, v207, s29, -v235
.p2align 3
    v_mfma_f32_16x16x32_bf16 v[176:179], a[96:99], a[0:3], 0
    s_barrier
    v_mov_b32 v240, v236
    v_add_f32 v238, v238, v196
    v_mfma_f32_16x16x32_bf16 v[176:179], a[100:103], a[4:7], v[176:179]
    ds_read_b64_tr_b16 a[144:145], v226 offset:36864
    ds_read_b64_tr_b16 a[146:147], v226 offset:43008
    v_mfma_f32_16x16x32_bf16 v[176:179], a[104:107], a[8:11], v[176:179]
    s_mov_b32 m0, s92
    v_exp_f32 v198, v198
    v_mfma_f32_16x16x32_bf16 v[176:179], a[108:111], a[12:15], v[176:179]
    buffer_load_dwordx4 v230, s[8:11], 0 offen offset:0 nt lds
    v_add_f32 v238, v238, v197
    v_mfma_f32_16x16x32_bf16 v[176:179], a[112:115], a[16:19], v[176:179]
    ds_read_b64_tr_b16 a[148:149], v227 offset:36864
    v_cvt_pk_bf16_f32 v218, v196, v197
    v_mfma_f32_16x16x32_bf16 v[176:179], a[116:119], a[20:23], v[176:179]
    s_mov_b32 s42, 0x53800000
    v_exp_f32 v199, v199
    v_mfma_f32_16x16x32_bf16 v[180:183], a[120:123], a[0:3], 0
    ds_read_b64_tr_b16 a[150:151], v227 offset:43008
    v_add_f32 v238, v238, v198
    v_mfma_f32_16x16x32_bf16 v[180:183], a[124:127], a[4:7], v[180:183]
    ds_read_b64_tr_b16 a[152:153], v228 offset:36864
    v_add_f32 v238, v238, v199
    v_mfma_f32_16x16x32_bf16 v[180:183], a[128:131], a[8:11], v[180:183]
    s_mov_b32 m0, s93
    v_exp_f32 v200, v200
    v_mfma_f32_16x16x32_bf16 v[180:183], a[132:135], a[12:15], v[180:183]
    buffer_load_dwordx4 v230, s[8:11], 0 offen offset:128 nt lds
    v_cvt_pk_bf16_f32 v219, v198, v199
    v_mfma_f32_16x16x32_bf16 v[180:183], a[136:139], a[16:19], v[180:183]
    ds_read_b64_tr_b16 a[154:155], v228 offset:43008
    v_add_f32 v239, v239, v200
    v_mfma_f32_16x16x32_bf16 v[180:183], a[140:143], a[20:23], v[180:183]
    s_sub_u32 s31, s31, 1
    v_exp_f32 v201, v201
    v_mfma_f32_16x16x32_bf16 v[184:187], a[96:99], a[24:27], 0
    ds_read_b64_tr_b16 a[156:157], v229 offset:36864
    v_add_f32 v239, v239, v201
    v_mfma_f32_16x16x32_bf16 v[184:187], a[100:103], a[28:31], v[184:187]
    ds_read_b64_tr_b16 a[158:159], v229 offset:43008
    v_cvt_pk_bf16_f32 v220, v200, v201
    v_mfma_f32_16x16x32_bf16 v[184:187], a[104:107], a[32:35], v[184:187]
    s_mov_b32 m0, s94
    v_exp_f32 v202, v202
    v_mfma_f32_16x16x32_bf16 v[184:187], a[108:111], a[36:39], v[184:187]
    buffer_load_dwordx4 v230, s[8:11], 0 offen offset:256 nt lds
    v_max3_f32 v232, v176, v177, v178
    v_mfma_f32_16x16x32_bf16 v[184:187], a[112:115], a[40:43], v[184:187]
    ds_read_b64_tr_b16 a[160:161], v226 offset:37888
    v_max3_f32 v232, v232, v179, v180
    v_mfma_f32_16x16x32_bf16 v[184:187], a[116:119], a[44:47], v[184:187]
    s_add_u32 s32, s32, 32
    v_exp_f32 v203, v203
    v_mfma_f32_16x16x32_bf16 v[188:191], a[120:123], a[24:27], 0
    ds_read_b64_tr_b16 a[162:163], v226 offset:44032
    v_max3_f32 v232, v232, v181, v182
    v_mfma_f32_16x16x32_bf16 v[188:191], a[124:127], a[28:31], v[188:191]
    ds_read_b64_tr_b16 a[164:165], v227 offset:37888
    v_max_f32 v232, v232, v183
    v_mfma_f32_16x16x32_bf16 v[188:191], a[128:131], a[32:35], v[188:191]
    s_mul_hi_u32 s38, s32, 0x55555556
    v_exp_f32 v204, v204
    v_mfma_f32_16x16x32_bf16 v[188:191], a[132:135], a[36:39], v[188:191]
    ds_read_b64_tr_b16 a[166:167], v227 offset:44032
    v_mov_b32 v236, v232
    v_mfma_f32_16x16x32_bf16 v[188:191], a[136:139], a[40:43], v[188:191]
    ds_read_b64_tr_b16 a[168:169], v228 offset:37888
    ds_read_b64_tr_b16 a[170:171], v228 offset:44032
    v_mfma_f32_16x16x32_bf16 v[188:191], a[140:143], a[44:47], v[188:191]
    s_mul_i32 s38, s38, 196608
    v_exp_f32 v205, v205
    v_mfma_f32_16x16x32_bf16 v[192:195], a[96:99], a[48:51], 0
    ds_read_b64_tr_b16 a[172:173], v229 offset:37888
    v_permlane32_swap_b32 v232, v236
    v_mfma_f32_16x16x32_bf16 v[192:195], a[100:103], a[52:55], v[192:195]
    ds_read_b64_tr_b16 a[174:175], v229 offset:44032
    v_max_f32 v232, v232, v236
    v_mfma_f32_16x16x32_bf16 v[192:195], a[104:107], a[56:59], v[192:195]
    s_add_u32 s38, s38, s33
    v_exp_f32 v206, v206
    v_mov_b32 v236, v232
    v_mfma_f32_16x16x32_bf16 v[192:195], a[108:111], a[60:63], v[192:195]
    ds_read_b64_tr_b16 a[176:177], v226 offset:38912
    v_add_f32 v239, v239, v202
    v_mfma_f32_16x16x32_bf16 v[192:195], a[112:115], a[64:67], v[192:195]
    ds_read_b64_tr_b16 a[178:179], v226 offset:45056
    v_permlane16_swap_b32 v232, v236
    v_mfma_f32_16x16x32_bf16 v[192:195], a[116:119], a[68:71], v[192:195]
    s_add_u32 s38, s38, 196608
    v_exp_f32 v207, v207
    v_max_f32 v232, v232, v236
    v_mfma_f32_16x16x32_bf16 v[196:199], a[120:123], a[48:51], 0
    ds_read_b64_tr_b16 a[180:181], v227 offset:38912
    v_mul_f32 v232, s29, v232
    v_mfma_f32_16x16x32_bf16 v[196:199], a[124:127], a[52:55], v[196:199]
    ds_read_b64_tr_b16 a[182:183], v227 offset:45056
    v_fma_f32 v176, v176, s29, -v232
    v_mfma_f32_16x16x32_bf16 v[196:199], a[128:131], a[56:59], v[196:199]
    s_add_u32 s25, s6, s38
    v_exp_f32 v176, v176
    v_mfma_f32_16x16x32_bf16 v[196:199], a[132:135], a[60:63], v[196:199]
    ds_read_b64_tr_b16 a[184:185], v228 offset:38912
    v_fma_f32 v177, v177, s29, -v232
    v_mfma_f32_16x16x32_bf16 v[196:199], a[136:139], a[64:67], v[196:199]
    ds_read_b64_tr_b16 a[186:187], v228 offset:45056
    v_add_f32 v239, v239, v203
    v_mfma_f32_16x16x32_bf16 v[196:199], a[140:143], a[68:71], v[196:199]
    s_add_u32 s26, s54, s38
    v_exp_f32 v177, v177
    v_cvt_pk_bf16_f32 v221, v202, v203
    v_add_f32 v239, v239, v204
    v_add_f32 v239, v239, v205
    v_cvt_pk_bf16_f32 v222, v204, v205
    v_add_f32 v239, v239, v206
    v_add_f32 v239, v239, v207
    v_cvt_pk_bf16_f32 v223, v206, v207
    v_mfma_f32_16x16x32_bf16 v[200:203], a[96:99], a[72:75], 0
    ds_read_b64_tr_b16 a[188:189], v229 offset:38912
    v_fma_f32 v178, v178, s29, -v232
    v_mfma_f32_16x16x32_bf16 v[200:203], a[100:103], a[76:79], v[200:203]
    ds_read_b64_tr_b16 a[190:191], v229 offset:45056
    v_fma_f32 v179, v179, s29, -v232
    v_mfma_f32_16x16x32_bf16 v[200:203], a[104:107], a[80:83], v[200:203]
    s_add_u32 s41, s32, 32
    v_exp_f32 v178, v178
    v_mfma_f32_16x16x32_bf16 v[200:203], a[108:111], a[84:87], v[200:203]
    s_min_u32 s41, s41, 767
    v_max3_f32 v233, v184, v185, v186
    v_fma_f32 v180, v180, s29, -v232
    v_mfma_f32_16x16x32_bf16 v[200:203], a[112:115], a[88:91], v[200:203]
    s_mul_hi_u32 s38, s41, 0x55555556
    s_mul_i32 s38, s38, 196608
    s_add_u32 s38, s38, s33
    s_add_u32 s88, s6, s38
    s_addc_u32 s89, s7, 0
    v_mfma_f32_16x16x32_bf16 v[200:203], a[116:119], a[92:95], v[200:203]
    s_add_u32 s8, s8, 12288
    v_exp_f32 v179, v179
    v_mfma_f32_16x16x32_bf16 v[204:207], a[120:123], a[72:75], 0
    s_addc_u32 s9, s9, 0
    v_max3_f32 v233, v233, v187, v188
    v_mov_b32 v241, v237
    v_mfma_f32_16x16x32_bf16 v[204:207], a[124:127], a[76:79], v[204:207]
    s_add_u32 s90, s54, s38
    v_max3_f32 v233, v233, v189, v190
    v_fma_f32 v181, v181, s29, -v232
    v_mfma_f32_16x16x32_bf16 v[204:207], a[128:131], a[80:83], v[204:207]
    s_addc_u32 s91, s55, 0
    v_exp_f32 v180, v180
    v_mfma_f32_16x16x32_bf16 v[204:207], a[132:135], a[84:87], v[204:207]
    s_mul_i32 s39, s41, 98304
    v_max_f32 v233, v233, v191
    v_fma_f32 v182, v182, s29, -v232
    v_mfma_f32_16x16x32_bf16 v[204:207], a[136:139], a[88:91], v[204:207]
    s_mul_i32 s40, s24, 24576
    v_mov_b32 v237, v233
    v_fma_f32 v183, v183, s29, -v232
    v_mfma_f32_16x16x32_bf16 v[204:207], a[140:143], a[92:95], v[204:207]
    s_waitcnt vmcnt(9) lgkmcnt(0)
    v_exp_f32 v181, v181
    v_mfma_f32_16x16x32_bf16 v[0:3], v[208:211], a[144:147], v[0:3]
    s_barrier
    v_permlane32_swap_b32 v233, v237
    v_mfma_f32_16x16x32_bf16 v[4:7], v[208:211], a[148:151], v[4:7]
    ds_read_b128 a[96:99], v224 offset:12288
    v_max_f32 v233, v233, v237
    v_mfma_f32_16x16x32_bf16 v[8:11], v[208:211], a[152:155], v[8:11]
    s_mov_b32 m0, s101
    v_exp_f32 v182, v182
    v_mov_b32 v237, v233
    v_mfma_f32_16x16x32_bf16 v[12:15], v[208:211], a[156:159], v[12:15]
    buffer_load_dwordx4 v253, s[12:15], 0 offen offset:0 nt lds
    v_max3_f32 v234, v192, v193, v194
    v_mfma_f32_16x16x32_bf16 v[16:19], v[208:211], a[160:163], v[16:19]
    ds_read_b128 a[100:103], v225 offset:12288
    v_permlane16_swap_b32 v233, v237
    v_mfma_f32_16x16x32_bf16 v[20:23], v[208:211], a[164:167], v[20:23]
    s_add_u32 s39, s39, s40
    v_exp_f32 v183, v183
    v_max_f32 v233, v233, v237
    v_mfma_f32_16x16x32_bf16 v[24:27], v[208:211], a[168:171], v[24:27]
    s_add_u32 s16, s46, s39
    v_mul_f32 v233, s29, v233
    v_max3_f32 v234, v234, v195, v196
    v_mfma_f32_16x16x32_bf16 v[28:31], v[208:211], a[172:175], v[28:31]
    ds_read_b128 a[104:107], v224 offset:13312
    v_fma_f32 v184, v184, s29, -v233
    v_mfma_f32_16x16x32_bf16 v[32:35], v[208:211], a[176:179], v[32:35]
    s_mov_b32 m0, s37
    v_exp_f32 v184, v184
    v_mfma_f32_16x16x32_bf16 v[36:39], v[208:211], a[180:183], v[36:39]
    buffer_load_dwordx4 v253, s[12:15], 0 offen offset:128 nt lds
    v_fma_f32 v185, v185, s29, -v233
    v_mfma_f32_16x16x32_bf16 v[40:43], v[208:211], a[184:187], v[40:43]
    ds_read_b128 a[108:111], v225 offset:13312
    v_fma_f32 v186, v186, s29, -v233
    v_mfma_f32_16x16x32_bf16 a[192:195], v[208:211], a[188:191], a[192:195]
    s_addc_u32 s17, s47, 0
    v_exp_f32 v185, v185
    v_mfma_f32_16x16x32_bf16 v[44:47], v[212:215], a[144:147], v[44:47]
    s_cmp_gt_u32 s31, 1
    v_fma_f32 v187, v187, s29, -v233
    v_fma_f32 v188, v188, s29, -v233
    v_mfma_f32_16x16x32_bf16 v[48:51], v[212:215], a[148:151], v[48:51]
    ds_read_b128 a[112:115], v224 offset:14336
    v_max3_f32 v234, v234, v197, v198
    v_mfma_f32_16x16x32_bf16 v[52:55], v[212:215], a[152:155], v[52:55]
    s_mov_b32 m0, s3
    v_exp_f32 v186, v186
    v_mfma_f32_16x16x32_bf16 v[56:59], v[212:215], a[156:159], v[56:59]
    buffer_load_dwordx4 v253, s[12:15], 0 offen offset:256 nt lds
    v_mov_b32 v242, v238
    v_mfma_f32_16x16x32_bf16 v[60:63], v[212:215], a[160:163], v[60:63]
    ds_read_b128 a[116:119], v225 offset:14336
    v_max_f32 v234, v234, v199
    v_mfma_f32_16x16x32_bf16 v[64:67], v[212:215], a[164:167], v[64:67]
    s_cselect_b32 s27, 3072, 0
    v_exp_f32 v187, v187
    v_mfma_f32_16x16x32_bf16 v[68:71], v[212:215], a[168:171], v[68:71]
    s_cselect_b32 s18, 6144, 0
    v_fma_f32 v189, v189, s29, -v233
    v_mov_b32 v238, v234
    v_mfma_f32_16x16x32_bf16 v[72:75], v[212:215], a[172:175], v[72:75]
    ds_read_b128 a[120:123], v224 offset:18432
    s_mov_b32 s28, 0
    s_mov_b32 s35, s34
    s_mov_b32 s30, 7
    v_mfma_f32_16x16x32_bf16 v[76:79], v[212:215], a[176:179], v[76:79]
    s_add_u32 m0, s35, 0
    v_exp_f32 v188, v188
    v_mfma_f32_16x16x32_bf16 v[80:83], v[212:215], a[180:183], v[80:83]
    buffer_load_dwordx4 v230, s[16:19], 0 offen offset:0 nt lds
    v_fma_f32 v190, v190, s29, -v233
    v_mfma_f32_16x16x32_bf16 v[84:87], v[212:215], a[184:187], v[84:87]
    ds_read_b128 a[124:127], v225 offset:18432
    v_mov_b32 v243, v239
    v_mfma_f32_16x16x32_bf16 a[196:199], v[212:215], a[188:191], a[196:199]
    s_add_u32 s12, s12, 12288
    v_exp_f32 v189, v189
    v_mfma_f32_16x16x32_bf16 v[88:91], v[216:219], a[144:147], v[88:91]
    s_addc_u32 s13, s13, 0
    v_permlane32_swap_b32 v234, v238
    v_mfma_f32_16x16x32_bf16 v[92:95], v[216:219], a[148:151], v[92:95]
    ds_read_b128 a[128:131], v224 offset:19456
    v_max_f32 v234, v234, v238
    v_mfma_f32_16x16x32_bf16 v[96:99], v[216:219], a[152:155], v[96:99]
    s_add_u32 m0, s35, 896
    v_exp_f32 v190, v190
    v_mov_b32 v238, v234
    v_mfma_f32_16x16x32_bf16 v[100:103], v[216:219], a[156:159], v[100:103]
    buffer_load_dwordx4 v230, s[16:19], 0 offen offset:128 nt lds
    v_fma_f32 v191, v191, s29, -v233
    v_mfma_f32_16x16x32_bf16 v[104:107], v[216:219], a[160:163], v[104:107]
    ds_read_b128 a[132:135], v225 offset:19456
    v_permlane16_swap_b32 v234, v238
    v_mfma_f32_16x16x32_bf16 v[108:111], v[216:219], a[164:167], v[108:111]
    v_exp_f32 v191, v191
    v_permlane32_swap_b32 v240, v241
    v_permlane32_swap_b32 v242, v243
    v_max_f32 v234, v234, v238
    v_mfma_f32_16x16x32_bf16 v[112:115], v[216:219], a[168:171], v[112:115]
    v_mul_f32 v234, s29, v234
    v_add_f32 v240, v240, v241
    v_add_f32 v242, v242, v243
    v_mfma_f32_16x16x32_bf16 v[116:119], v[216:219], a[172:175], v[116:119]
    ds_read_b128 a[136:139], v224 offset:20480
    v_fma_f32 v192, v192, s29, -v234
    v_mfma_f32_16x16x32_bf16 v[120:123], v[216:219], a[176:179], v[120:123]
    s_add_u32 m0, s35, 1792
    v_exp_f32 v192, v192
    v_permlane16_swap_b32 v240, v242
    v_mfma_f32_16x16x32_bf16 v[124:127], v[216:219], a[180:183], v[124:127]
    buffer_load_dwordx4 v230, s[16:19], 0 offen offset:256 nt lds
    v_add_f32 v240, v240, v242
    v_mfma_f32_16x16x32_bf16 v[128:131], v[216:219], a[184:187], v[128:131]
    ds_read_b128 a[140:143], v225 offset:20480
    v_rcp_f32 v241, v240
    v_fma_f32 v193, v193, s29, -v234
    v_max3_f32 v235, v200, v201, v202
    v_mfma_f32_16x16x32_bf16 a[200:203], v[216:219], a[188:191], a[200:203]
    s_add_u32 s16, s16, 3072
    v_exp_f32 v193, v193
    v_max3_f32 v235, v235, v203, v204
    v_mfma_f32_16x16x32_bf16 v[132:135], v[220:223], a[144:147], v[132:135]
    s_addc_u32 s17, s17, 0
    v_max3_f32 v235, v235, v205, v206
    v_fma_f32 v194, v194, s29, -v234
    v_mfma_f32_16x16x32_bf16 v[136:139], v[220:223], a[148:151], v[136:139]
    ds_write_b32 v248, v241 offset:0
    v_max_f32 v235, v235, v207
    v_mfma_f32_16x16x32_bf16 v[140:143], v[220:223], a[152:155], v[140:143]
    s_add_u32 s35, s35, 3072
    v_exp_f32 v194, v194
    v_add_f32 v236, v176, v177
    v_cvt_pk_bf16_f32 v208, v176, v177
    v_add_f32 v236, v236, v178
    v_add_f32 v236, v236, v179
    v_cvt_pk_bf16_f32 v209, v178, v179
    v_add_f32 v236, v236, v180
    v_add_f32 v236, v236, v181
    v_cvt_pk_bf16_f32 v210, v180, v181
    v_add_f32 v236, v236, v182
    v_add_f32 v236, v236, v183
    v_cvt_pk_bf16_f32 v211, v182, v183
    v_add_f32 v237, v184, v185
    v_cvt_pk_bf16_f32 v212, v184, v185
    v_add_f32 v237, v237, v186
    v_add_f32 v237, v237, v187
    v_cvt_pk_bf16_f32 v213, v186, v187
    v_add_f32 v237, v237, v188
    v_add_f32 v237, v237, v189
    v_cvt_pk_bf16_f32 v214, v188, v189
    v_add_f32 v237, v237, v190
    v_add_f32 v237, v237, v191
    v_cvt_pk_bf16_f32 v215, v190, v191
    v_mov_b32 v239, v235
    v_cmp_nge_f32 vcc, s42, v240
    v_mfma_f32_16x16x32_bf16 v[144:147], v[220:223], a[156:159], v[144:147]
    ds_read_b128 v[176:179], v249 offset:0
    ds_read_b128 v[180:183], v249 offset:128
    v_mfma_f32_16x16x32_bf16 v[148:151], v[220:223], a[160:163], v[148:151]
    ds_read_b128 v[184:187], v249 offset:64
    ds_read_b128 v[188:191], v249 offset:192
    v_permlane32_swap_b32 v235, v239
    v_fma_f32 v195, v195, s29, -v234
    v_mfma_f32_16x16x32_bf16 v[152:155], v[220:223], a[164:167], v[152:155]
    v_exp_f32 v195, v195
    v_max_f32 v235, v235, v239
    v_mfma_f32_16x16x32_bf16 v[156:159], v[220:223], a[168:171], v[156:159]
    buffer_load_dword v252, v254, s[84:87], 0 offen
    v_mov_b32 v239, v235
    v_mfma_f32_16x16x32_bf16 v[160:163], v[220:223], a[172:175], v[160:163]
    s_mov_b32 s86, 0
    v_fma_f32 v196, v196, s29, -v234
    v_fma_f32 v197, v197, s29, -v234
    v_mfma_f32_16x16x32_bf16 v[164:167], v[220:223], a[176:179], v[164:167]
    s_cmp_lg_u64 vcc, 0
    v_exp_f32 v196, v196
    v_permlane16_swap_b32 v235, v239
    v_mfma_f32_16x16x32_bf16 v[168:171], v[220:223], a[180:183], v[168:171]
    s_cselect_b32 s42, 1, 0
    v_max_f32 v235, v235, v239
    v_add_f32 v238, v192, v193
    v_mfma_f32_16x16x32_bf16 v[172:175], v[220:223], a[184:187], v[172:175]
    s_lshl_b32 s42, s42, s51
    s_or_b32 s36, s36, s42
    s_add_u32 s51, s51, 1
    v_mul_f32 v235, s29, v235
    v_mfma_f32_16x16x32_bf16 a[204:207], v[220:223], a[188:191], a[204:207]
    s_waitcnt vmcnt(10) lgkmcnt(0)
    v_exp_f32 v197, v197
    v_cvt_pk_bf16_f32 v216, v192, v193
    v_add_f32 v238, v238, v194
    v_add_f32 v238, v238, v195
    v_cvt_pk_bf16_f32 v217, v194, v195
    v_fma_f32 v198, v198, s29, -v234
    v_fma_f32 v199, v199, s29, -v234
    v_mov_b32 v239, 0
    v_fma_f32 v200, v200, s29, -v235
    v_fma_f32 v201, v201, s29, -v235
    v_fma_f32 v202, v202, s29, -v235
    v_fma_f32 v203, v203, s29, -v235
    v_fma_f32 v204, v204, s29, -v235
    v_fma_f32 v205, v205, s29, -v235
    v_fma_f32 v206, v206, s29, -v235
    v_fma_f32 v207, v207, s29, -v235
    v_mov_b32 v231, v250
.p2align 3
    v_pk_mul_f32 v[0:1], v[0:1], v[176:177]
    v_pk_mul_f32 v[242:243], v[2:3], v[178:179]
    v_pk_mul_f32 v[2:3], v[4:5], v[176:177]
    v_pk_mul_f32 v[8:9], v[8:9], v[176:177]
    v_pk_mul_f32 v[12:13], v[12:13], v[176:177]
    v_cvt_pk_bf16_f32 v0, v0, v2
    v_cvt_pk_bf16_f32 v2, v1, v3
    v_cvt_pk_bf16_f32 v1, v8, v12
    v_cvt_pk_bf16_f32 v3, v9, v13
    v_pk_mul_f32 v[6:7], v[6:7], v[178:179]
    v_pk_mul_f32 v[10:11], v[10:11], v[178:179]
    v_pk_mul_f32 v[14:15], v[14:15], v[178:179]
    v_cvt_pk_bf16_f32 v4, v242, v6
    v_cvt_pk_bf16_f32 v6, v243, v7
    v_cvt_pk_bf16_f32 v5, v10, v14
    v_cvt_pk_bf16_f32 v7, v11, v15
    ds_write_b128 v246, v[0:3] offset:0
    v_pk_mul_f32 v[16:17], v[16:17], v[176:177]
    v_pk_mul_f32 v[242:243], v[18:19], v[178:179]
    v_pk_mul_f32 v[18:19], v[20:21], v[176:177]
    v_pk_mul_f32 v[24:25], v[24:25], v[176:177]
    v_pk_mul_f32 v[28:29], v[28:29], v[176:177]
    v_cvt_pk_bf16_f32 v16, v16, v18
    v_cvt_pk_bf16_f32 v18, v17, v19
    v_cvt_pk_bf16_f32 v17, v24, v28
    v_cvt_pk_bf16_f32 v19, v25, v29
    v_pk_mul_f32 v[22:23], v[22:23], v[178:179]
    v_pk_mul_f32 v[26:27], v[26:27], v[178:179]
    v_pk_mul_f32 v[30:31], v[30:31], v[178:179]
    v_cvt_pk_bf16_f32 v20, v242, v22
    v_cvt_pk_bf16_f32 v22, v243, v23
    v_cvt_pk_bf16_f32 v21, v26, v30
    v_cvt_pk_bf16_f32 v23, v27, v31
    ds_write_b128 v246, v[4:7] offset:512
    v_accvgpr_read_b32 v28, a192
    v_accvgpr_read_b32 v29, a193
    v_accvgpr_read_b32 v30, a194
    v_accvgpr_read_b32 v31, a195
    v_pk_mul_f32 v[32:33], v[32:33], v[176:177]
    v_pk_mul_f32 v[242:243], v[34:35], v[178:179]
    v_pk_mul_f32 v[34:35], v[36:37], v[176:177]
    v_pk_mul_f32 v[40:41], v[40:41], v[176:177]
    v_pk_mul_f32 v[28:29], v[28:29], v[176:177]
    v_cvt_pk_bf16_f32 v32, v32, v34
    v_cvt_pk_bf16_f32 v34, v33, v35
    v_cvt_pk_bf16_f32 v33, v40, v28
    v_cvt_pk_bf16_f32 v35, v41, v29
    v_pk_mul_f32 v[38:39], v[38:39], v[178:179]
    v_pk_mul_f32 v[42:43], v[42:43], v[178:179]
    v_pk_mul_f32 v[30:31], v[30:31], v[178:179]
    v_cvt_pk_bf16_f32 v36, v242, v38
    v_cvt_pk_bf16_f32 v38, v243, v39
    v_cvt_pk_bf16_f32 v37, v42, v30
    v_cvt_pk_bf16_f32 v39, v43, v31
    ds_write_b128 v246, v[16:19] offset:1024
    v_pk_mul_f32 v[44:45], v[44:45], v[180:181]
    v_pk_mul_f32 v[242:243], v[46:47], v[182:183]
    v_pk_mul_f32 v[46:47], v[48:49], v[180:181]
    v_pk_mul_f32 v[52:53], v[52:53], v[180:181]
    v_pk_mul_f32 v[56:57], v[56:57], v[180:181]
    v_cvt_pk_bf16_f32 v44, v44, v46
    v_cvt_pk_bf16_f32 v46, v45, v47
    v_cvt_pk_bf16_f32 v45, v52, v56
    v_cvt_pk_bf16_f32 v47, v53, v57
    v_pk_mul_f32 v[50:51], v[50:51], v[182:183]
    v_pk_mul_f32 v[54:55], v[54:55], v[182:183]
    v_pk_mul_f32 v[58:59], v[58:59], v[182:183]
    v_cvt_pk_bf16_f32 v48, v242, v50
    v_cvt_pk_bf16_f32 v50, v243, v51
    v_cvt_pk_bf16_f32 v49, v54, v58
    v_cvt_pk_bf16_f32 v51, v55, v59
    ds_write_b128 v246, v[20:23] offset:1536
    v_pk_mul_f32 v[60:61], v[60:61], v[180:181]
    v_pk_mul_f32 v[242:243], v[62:63], v[182:183]
    v_pk_mul_f32 v[62:63], v[64:65], v[180:181]
    v_pk_mul_f32 v[68:69], v[68:69], v[180:181]
    v_pk_mul_f32 v[72:73], v[72:73], v[180:181]
    v_cvt_pk_bf16_f32 v60, v60, v62
    v_cvt_pk_bf16_f32 v62, v61, v63
    v_cvt_pk_bf16_f32 v61, v68, v72
    v_cvt_pk_bf16_f32 v63, v69, v73
    v_pk_mul_f32 v[66:67], v[66:67], v[182:183]
    v_pk_mul_f32 v[70:71], v[70:71], v[182:183]
    v_pk_mul_f32 v[74:75], v[74:75], v[182:183]
    v_cvt_pk_bf16_f32 v64, v242, v66
    v_cvt_pk_bf16_f32 v66, v243, v67
    v_cvt_pk_bf16_f32 v65, v70, v74
    v_cvt_pk_bf16_f32 v67, v71, v75
    ds_write_b128 v246, v[32:35] offset:2048
    v_accvgpr_read_b32 v72, a196
    v_accvgpr_read_b32 v73, a197
    v_accvgpr_read_b32 v74, a198
    v_accvgpr_read_b32 v75, a199
    v_pk_mul_f32 v[76:77], v[76:77], v[180:181]
    v_pk_mul_f32 v[242:243], v[78:79], v[182:183]
    v_pk_mul_f32 v[78:79], v[80:81], v[180:181]
    v_pk_mul_f32 v[84:85], v[84:85], v[180:181]
    v_pk_mul_f32 v[72:73], v[72:73], v[180:181]
    v_cvt_pk_bf16_f32 v76, v76, v78
    v_cvt_pk_bf16_f32 v78, v77, v79
    v_cvt_pk_bf16_f32 v77, v84, v72
    v_cvt_pk_bf16_f32 v79, v85, v73
    v_pk_mul_f32 v[82:83], v[82:83], v[182:183]
    v_pk_mul_f32 v[86:87], v[86:87], v[182:183]
    v_pk_mul_f32 v[74:75], v[74:75], v[182:183]
    v_cvt_pk_bf16_f32 v80, v242, v82
    v_cvt_pk_bf16_f32 v82, v243, v83
    v_cvt_pk_bf16_f32 v81, v86, v74
    v_cvt_pk_bf16_f32 v83, v87, v75
    ds_write_b128 v246, v[36:39] offset:2560
    v_pk_mul_f32 v[88:89], v[88:89], v[184:185]
    v_pk_mul_f32 v[242:243], v[90:91], v[186:187]
    v_pk_mul_f32 v[90:91], v[92:93], v[184:185]
    v_pk_mul_f32 v[96:97], v[96:97], v[184:185]
    v_pk_mul_f32 v[100:101], v[100:101], v[184:185]
    v_cvt_pk_bf16_f32 v88, v88, v90
    v_cvt_pk_bf16_f32 v90, v89, v91
    v_cvt_pk_bf16_f32 v89, v96, v100
    v_cvt_pk_bf16_f32 v91, v97, v101
    v_pk_mul_f32 v[94:95], v[94:95], v[186:187]
    v_pk_mul_f32 v[98:99], v[98:99], v[186:187]
    v_pk_mul_f32 v[102:103], v[102:103], v[186:187]
    v_cvt_pk_bf16_f32 v92, v242, v94
    v_cvt_pk_bf16_f32 v94, v243, v95
    v_cvt_pk_bf16_f32 v93, v98, v102
    v_cvt_pk_bf16_f32 v95, v99, v103
    ds_write_b128 v246, v[44:47] offset:6144
    v_pk_mul_f32 v[104:105], v[104:105], v[184:185]
    v_pk_mul_f32 v[242:243], v[106:107], v[186:187]
    v_pk_mul_f32 v[106:107], v[108:109], v[184:185]
    v_pk_mul_f32 v[112:113], v[112:113], v[184:185]
    v_pk_mul_f32 v[116:117], v[116:117], v[184:185]
    v_cvt_pk_bf16_f32 v104, v104, v106
    v_cvt_pk_bf16_f32 v106, v105, v107
    v_cvt_pk_bf16_f32 v105, v112, v116
    v_cvt_pk_bf16_f32 v107, v113, v117
    v_pk_mul_f32 v[110:111], v[110:111], v[186:187]
    v_pk_mul_f32 v[114:115], v[114:115], v[186:187]
    v_pk_mul_f32 v[118:119], v[118:119], v[186:187]
    v_cvt_pk_bf16_f32 v108, v242, v110
    v_cvt_pk_bf16_f32 v110, v243, v111
    v_cvt_pk_bf16_f32 v109, v114, v118
    v_cvt_pk_bf16_f32 v111, v115, v119
    ds_write_b128 v246, v[48:51] offset:6656
    v_accvgpr_read_b32 v116, a200
    v_accvgpr_read_b32 v117, a201
    v_accvgpr_read_b32 v118, a202
    v_accvgpr_read_b32 v119, a203
    v_pk_mul_f32 v[120:121], v[120:121], v[184:185]
    v_pk_mul_f32 v[242:243], v[122:123], v[186:187]
    v_pk_mul_f32 v[122:123], v[124:125], v[184:185]
    v_pk_mul_f32 v[128:129], v[128:129], v[184:185]
    v_pk_mul_f32 v[116:117], v[116:117], v[184:185]
    v_cvt_pk_bf16_f32 v120, v120, v122
    v_cvt_pk_bf16_f32 v122, v121, v123
    v_cvt_pk_bf16_f32 v121, v128, v116
    v_cvt_pk_bf16_f32 v123, v129, v117
    v_pk_mul_f32 v[126:127], v[126:127], v[186:187]
    v_pk_mul_f32 v[130:131], v[130:131], v[186:187]
    v_pk_mul_f32 v[118:119], v[118:119], v[186:187]
    v_cvt_pk_bf16_f32 v124, v242, v126
    v_cvt_pk_bf16_f32 v126, v243, v127
    v_cvt_pk_bf16_f32 v125, v130, v118
    v_cvt_pk_bf16_f32 v127, v131, v119
    ds_write_b128 v246, v[60:63] offset:7168
    v_pk_mul_f32 v[132:133], v[132:133], v[188:189]
    v_pk_mul_f32 v[242:243], v[134:135], v[190:191]
    v_pk_mul_f32 v[134:135], v[136:137], v[188:189]
    v_pk_mul_f32 v[140:141], v[140:141], v[188:189]
    v_pk_mul_f32 v[144:145], v[144:145], v[188:189]
    v_cvt_pk_bf16_f32 v132, v132, v134
    v_cvt_pk_bf16_f32 v134, v133, v135
    v_cvt_pk_bf16_f32 v133, v140, v144
    v_cvt_pk_bf16_f32 v135, v141, v145
    v_pk_mul_f32 v[138:139], v[138:139], v[190:191]
    v_pk_mul_f32 v[142:143], v[142:143], v[190:191]
    v_pk_mul_f32 v[146:147], v[146:147], v[190:191]
    v_cvt_pk_bf16_f32 v136, v242, v138
    v_cvt_pk_bf16_f32 v138, v243, v139
    v_cvt_pk_bf16_f32 v137, v142, v146
    v_cvt_pk_bf16_f32 v139, v143, v147
    ds_write_b128 v246, v[64:67] offset:7680
    v_pk_mul_f32 v[148:149], v[148:149], v[188:189]
    v_pk_mul_f32 v[242:243], v[150:151], v[190:191]
    v_pk_mul_f32 v[150:151], v[152:153], v[188:189]
    v_pk_mul_f32 v[156:157], v[156:157], v[188:189]
    v_pk_mul_f32 v[160:161], v[160:161], v[188:189]
    v_cvt_pk_bf16_f32 v148, v148, v150
    v_cvt_pk_bf16_f32 v150, v149, v151
    v_cvt_pk_bf16_f32 v149, v156, v160
    v_cvt_pk_bf16_f32 v151, v157, v161
    v_pk_mul_f32 v[154:155], v[154:155], v[190:191]
    v_pk_mul_f32 v[158:159], v[158:159], v[190:191]
    v_pk_mul_f32 v[162:163], v[162:163], v[190:191]
    v_cvt_pk_bf16_f32 v152, v242, v154
    v_cvt_pk_bf16_f32 v154, v243, v155
    v_cvt_pk_bf16_f32 v153, v158, v162
    v_cvt_pk_bf16_f32 v155, v159, v163
    ds_write_b128 v246, v[76:79] offset:8192
    v_accvgpr_read_b32 v160, a204
    v_accvgpr_read_b32 v161, a205
    v_accvgpr_read_b32 v162, a206
    v_accvgpr_read_b32 v163, a207
    v_pk_mul_f32 v[164:165], v[164:165], v[188:189]
    v_pk_mul_f32 v[242:243], v[166:167], v[190:191]
    v_pk_mul_f32 v[166:167], v[168:169], v[188:189]
    v_pk_mul_f32 v[172:173], v[172:173], v[188:189]
    v_pk_mul_f32 v[160:161], v[160:161], v[188:189]
    v_cvt_pk_bf16_f32 v164, v164, v166
    v_cvt_pk_bf16_f32 v166, v165, v167
    v_cvt_pk_bf16_f32 v165, v172, v160
    v_cvt_pk_bf16_f32 v167, v173, v161
    v_pk_mul_f32 v[170:171], v[170:171], v[190:191]
    v_pk_mul_f32 v[174:175], v[174:175], v[190:191]
    v_pk_mul_f32 v[162:163], v[162:163], v[190:191]
    v_cvt_pk_bf16_f32 v168, v242, v170
    v_cvt_pk_bf16_f32 v170, v243, v171
    v_cvt_pk_bf16_f32 v169, v174, v162
    v_cvt_pk_bf16_f32 v171, v175, v163
    ds_write_b128 v246, v[80:83] offset:8704
.p2align 3
L_Z:
    v_mfma_f32_16x16x32_bf16 v[176:179], a[96:99], a[0:3], 0
    s_barrier
    v_mfma_f32_16x16x32_bf16 v[176:179], a[100:103], a[4:7], v[176:179]
    ds_read_b64_tr_b16 a[144:145], v226 offset:24576
    ds_read_b64_tr_b16 a[146:147], v226 offset:30720
    ds_write_b128 v246, v[88:91] offset:12288
    v_mfma_f32_16x16x32_bf16 v[176:179], a[104:107], a[8:11], v[176:179]
    s_mov_b32 m0, s95
    v_exp_f32 v198, v198
    v_mfma_f32_16x16x32_bf16 v[176:179], a[108:111], a[12:15], v[176:179]
    buffer_load_dwordx4 v230, s[8:11], 0 offen offset:0 nt lds
    v_mfma_f32_16x16x32_bf16 v[176:179], a[112:115], a[16:19], v[176:179]
    ds_read_b64_tr_b16 a[148:149], v227 offset:24576
    v_add_f32 v238, v238, v196
    v_mfma_f32_16x16x32_bf16 v[176:179], a[116:119], a[20:23], v[176:179]
    v_exp_f32 v199, v199
    v_mfma_f32_16x16x32_bf16 v[180:183], a[120:123], a[0:3], 0
    ds_read_b64_tr_b16 a[208:209], v231 offset:0
    ds_read_b64_tr_b16 a[210:211], v231 offset:64
    v_mfma_f32_16x16x32_bf16 v[180:183], a[124:127], a[4:7], v[180:183]
    ds_read_b64_tr_b16 a[212:213], v231 offset:1024
    ds_read_b64_tr_b16 a[214:215], v231 offset:1088
    ds_write_b128 v246, v[92:95] offset:12800
    v_mfma_f32_16x16x32_bf16 v[180:183], a[128:131], a[8:11], v[180:183]
    s_mov_b32 m0, s96
    v_exp_f32 v200, v200
    v_mfma_f32_16x16x32_bf16 v[180:183], a[132:135], a[12:15], v[180:183]
    buffer_load_dwordx4 v230, s[8:11], 0 offen offset:128 nt lds
    v_add_f32 v238, v238, v197
    v_mfma_f32_16x16x32_bf16 v[180:183], a[136:139], a[16:19], v[180:183]
    ds_read_b64_tr_b16 a[150:151], v227 offset:30720
    v_cvt_pk_bf16_f32 v218, v196, v197
    v_mfma_f32_16x16x32_bf16 v[180:183], a[140:143], a[20:23], v[180:183]
    v_exp_f32 v201, v201
    v_mfma_f32_16x16x32_bf16 v[184:187], a[96:99], a[24:27], 0
    ds_read_b64_tr_b16 a[216:217], v231 offset:2048
    ds_read_b64_tr_b16 a[218:219], v231 offset:2112
    v_mfma_f32_16x16x32_bf16 v[184:187], a[100:103], a[28:31], v[184:187]
    ds_read_b64_tr_b16 a[152:153], v228 offset:24576
    ds_write_b128 v246, v[104:107] offset:13312
    v_mfma_f32_16x16x32_bf16 v[184:187], a[104:107], a[32:35], v[184:187]
    s_mov_b32 m0, s97
    v_exp_f32 v202, v202
    v_mfma_f32_16x16x32_bf16 v[184:187], a[108:111], a[36:39], v[184:187]
    buffer_load_dwordx4 v230, s[8:11], 0 offen offset:256 nt lds
    v_add_f32 v238, v238, v198
    v_mfma_f32_16x16x32_bf16 v[184:187], a[112:115], a[40:43], v[184:187]
    ds_read_b64_tr_b16 a[154:155], v228 offset:30720
    v_add_f32 v238, v238, v199
    v_mfma_f32_16x16x32_bf16 v[184:187], a[116:119], a[44:47], v[184:187]
    s_add_u32 s8, s8, 12288
    v_exp_f32 v203, v203
    v_mfma_f32_16x16x32_bf16 v[188:191], a[120:123], a[24:27], 0
    ds_read_b64_tr_b16 a[156:157], v229 offset:24576
    ds_read_b64_tr_b16 a[158:159], v229 offset:30720
    v_mfma_f32_16x16x32_bf16 v[188:191], a[124:127], a[28:31], v[188:191]
    ds_read_b64_tr_b16 a[160:161], v226 offset:25600
    ds_write_b128 v246, v[108:111] offset:13824
    v_mfma_f32_16x16x32_bf16 v[188:191], a[128:131], a[32:35], v[188:191]
    s_waitcnt lgkmcnt(7)
    v_exp_f32 v204, v204
    v_mfma_f32_16x16x32_bf16 v[188:191], a[132:135], a[36:39], v[188:191]
    buffer_store_dwordx4 a[208:211], v247, s[20:23], s28 offen offset:0 sc1
    v_cvt_pk_bf16_f32 v219, v198, v199
    v_fma_f32 v176, v176, s29, -v232
    v_fma_f32 v177, v177, s29, -v232
    v_add_f32 v239, v239, v200
    v_mfma_f32_16x16x32_bf16 v[188:191], a[136:139], a[40:43], v[188:191]
    ds_read_b64_tr_b16 a[162:163], v226 offset:31744
    v_add_f32 v239, v239, v201
    v_mfma_f32_16x16x32_bf16 v[188:191], a[140:143], a[44:47], v[188:191]
    s_addc_u32 s9, s9, 0
    v_exp_f32 v205, v205
    v_mfma_f32_16x16x32_bf16 v[192:195], a[96:99], a[48:51], 0
    ds_read_b64_tr_b16 a[164:165], v227 offset:25600
    v_cvt_pk_bf16_f32 v220, v200, v201
    v_mfma_f32_16x16x32_bf16 v[192:195], a[100:103], a[52:55], v[192:195]
    ds_read_b64_tr_b16 a[166:167], v227 offset:31744
    ds_write_b128 v246, v[120:123] offset:14336
    v_mfma_f32_16x16x32_bf16 v[192:195], a[104:107], a[56:59], v[192:195]
    s_mul_hi_u32 s43, s32, 0x55555556
    v_exp_f32 v206, v206
    v_mfma_f32_16x16x32_bf16 v[192:195], a[108:111], a[60:63], v[192:195]
    ds_read_b64_tr_b16 a[168:169], v228 offset:25600
    ds_read_b64_tr_b16 a[170:171], v228 offset:31744
    v_mfma_f32_16x16x32_bf16 v[192:195], a[112:115], a[64:67], v[192:195]
    ds_read_b64_tr_b16 a[172:173], v229 offset:25600
    v_add_f32 v239, v239, v202
    v_mfma_f32_16x16x32_bf16 v[192:195], a[116:119], a[68:71], v[192:195]
    s_mul_i32 s44, s43, 3
    v_exp_f32 v207, v207
    v_mfma_f32_16x16x32_bf16 v[196:199], a[120:123], a[48:51], 0
    ds_read_b64_tr_b16 a[174:175], v229 offset:31744
    v_add_f32 v239, v239, v203
    v_mfma_f32_16x16x32_bf16 v[196:199], a[124:127], a[52:55], v[196:199]
    ds_read_b64_tr_b16 a[176:177], v226 offset:26624
    ds_write_b128 v246, v[124:127] offset:14848
    v_mfma_f32_16x16x32_bf16 v[196:199], a[128:131], a[56:59], v[196:199]
    s_sub_u32 s40, s32, s44
    v_exp_f32 v176, v176
    v_mfma_f32_16x16x32_bf16 v[196:199], a[132:135], a[60:63], v[196:199]
    buffer_store_dwordx4 a[212:215], v247, s[20:23], s28 offen offset:128 sc1
    v_cvt_pk_bf16_f32 v221, v202, v203
    v_add_f32 v239, v239, v204
    v_add_f32 v239, v239, v205
    v_cvt_pk_bf16_f32 v222, v204, v205
    v_mfma_f32_16x16x32_bf16 v[196:199], a[136:139], a[64:67], v[196:199]
    ds_read_b64_tr_b16 a[178:179], v226 offset:32768
    v_add_f32 v239, v239, v206
    v_mfma_f32_16x16x32_bf16 v[196:199], a[140:143], a[68:71], v[196:199]
    s_mul_i32 s43, s43, 196608
    v_exp_f32 v177, v177
    v_add_f32 v239, v239, v207
    v_cvt_pk_bf16_f32 v223, v206, v207
    v_mfma_f32_16x16x32_bf16 v[200:203], a[96:99], a[72:75], 0
    ds_read_b64_tr_b16 a[180:181], v227 offset:26624
    ds_read_b64_tr_b16 a[182:183], v227 offset:32768
    v_mfma_f32_16x16x32_bf16 v[200:203], a[100:103], a[76:79], v[200:203]
    ds_read_b64_tr_b16 a[184:185], v228 offset:26624
    ds_write_b128 v246, v[132:135] offset:18432
    v_fma_f32 v178, v178, s29, -v232
    v_mfma_f32_16x16x32_bf16 v[200:203], a[104:107], a[80:83], v[200:203]
    s_lshl_b32 s44, s31, 8
    v_exp_f32 v178, v178
    v_mfma_f32_16x16x32_bf16 v[200:203], a[108:111], a[84:87], v[200:203]
    ds_read_b64_tr_b16 a[186:187], v228 offset:32768
    v_fma_f32 v179, v179, s29, -v232
    v_mfma_f32_16x16x32_bf16 v[200:203], a[112:115], a[88:91], v[200:203]
    ds_read_b64_tr_b16 a[188:189], v229 offset:26624
    v_fma_f32 v180, v180, s29, -v232
    v_mfma_f32_16x16x32_bf16 v[200:203], a[116:119], a[92:95], v[200:203]
    s_add_u32 s44, s44, s2
    v_exp_f32 v179, v179
    v_mfma_f32_16x16x32_bf16 v[204:207], a[120:123], a[72:75], 0
    ds_read_b64_tr_b16 a[190:191], v229 offset:32768
    v_fma_f32 v181, v181, s29, -v232
    v_mfma_f32_16x16x32_bf16 v[204:207], a[124:127], a[76:79], v[204:207]
    ds_write_b128 v246, v[136:139] offset:18944
    v_mfma_f32_16x16x32_bf16 v[204:207], a[128:131], a[80:83], v[204:207]
    s_cmp_lt_u32 s44, 272
    v_exp_f32 v180, v180
    v_mfma_f32_16x16x32_bf16 v[204:207], a[132:135], a[84:87], v[204:207]
    buffer_store_dwordx4 a[216:219], v247, s[20:23], s28 offen offset:256 sc1
    v_fma_f32 v182, v182, s29, -v232
    v_fma_f32 v183, v183, s29, -v232
    v_fma_f32 v184, v184, s29, -v233
    v_fma_f32 v185, v185, s29, -v233
    v_mfma_f32_16x16x32_bf16 v[204:207], a[136:139], a[88:91], v[204:207]
    s_cselect_b32 s44, 3, 2
    v_fma_f32 v186, v186, s29, -v233
    v_fma_f32 v187, v187, s29, -v233
    v_mfma_f32_16x16x32_bf16 v[204:207], a[140:143], a[92:95], v[204:207]
    s_waitcnt vmcnt(13) lgkmcnt(1)
    v_exp_f32 v181, v181
    v_mfma_f32_16x16x32_bf16 v[0:3], v[208:211], a[144:147], 0
    s_barrier
    v_mfma_f32_16x16x32_bf16 v[4:7], v[208:211], a[148:151], 0
    ds_read_b128 a[96:99], v224 offset:0
    ds_write_b128 v246, v[148:151] offset:19456
    v_mfma_f32_16x16x32_bf16 v[8:11], v[208:211], a[152:155], 0
    s_mov_b32 m0, s98
    v_exp_f32 v182, v182
    v_mfma_f32_16x16x32_bf16 v[12:15], v[208:211], a[156:159], 0
    buffer_load_dwordx4 v253, s[12:15], 0 offen offset:0 nt lds
    v_fma_f32 v188, v188, s29, -v233
    v_mfma_f32_16x16x32_bf16 v[16:19], v[208:211], a[160:163], 0
    ds_read_b128 a[100:103], v225 offset:0
    v_fma_f32 v189, v189, s29, -v233
    v_mfma_f32_16x16x32_bf16 v[20:23], v[208:211], a[164:167], 0
    s_subb_u32 s40, s40, 0
    v_exp_f32 v183, v183
    v_mfma_f32_16x16x32_bf16 v[24:27], v[208:211], a[168:171], 0
    s_mul_i32 s44, s44, 1024
    v_fma_f32 v190, v190, s29, -v233
    v_fma_f32 v191, v191, s29, -v233
    v_mfma_f32_16x16x32_bf16 v[28:31], v[208:211], a[172:175], 0
    ds_read_b128 a[104:107], v224 offset:1024
    ds_write_b128 v246, v[152:155] offset:19968
    v_mfma_f32_16x16x32_bf16 v[32:35], v[208:211], a[176:179], 0
    s_mov_b32 m0, s99
    v_exp_f32 v184, v184
    v_mfma_f32_16x16x32_bf16 v[36:39], v[208:211], a[180:183], 0
    buffer_load_dwordx4 v253, s[12:15], 0 offen offset:128 nt lds
    v_fma_f32 v192, v192, s29, -v234
    v_mfma_f32_16x16x32_bf16 v[40:43], v[208:211], a[184:187], 0
    ds_read_b128 a[108:111], v225 offset:1024
    v_fma_f32 v193, v193, s29, -v234
    v_mfma_f32_16x16x32_bf16 a[192:195], v[208:211], a[188:191], 0
    s_lshl_b32 s40, s40, 1
    v_exp_f32 v185, v185
    v_mfma_f32_16x16x32_bf16 v[44:47], v[212:215], a[144:147], 0
    s_bitcmp1_b32 s24, 0
    v_fma_f32 v194, v194, s29, -v234
    v_fma_f32 v195, v195, s29, -v234
    v_mfma_f32_16x16x32_bf16 v[48:51], v[212:215], a[148:151], 0
    ds_read_b128 a[112:115], v224 offset:2048
    ds_write_b128 v246, v[164:167] offset:20480
    v_mfma_f32_16x16x32_bf16 v[52:55], v[212:215], a[152:155], 0
    s_mov_b32 m0, s100
    v_exp_f32 v186, v186
    v_mfma_f32_16x16x32_bf16 v[56:59], v[212:215], a[156:159], 0
    buffer_load_dwordx4 v253, s[12:15], 0 offen offset:256 nt lds
    v_fma_f32 v196, v196, s29, -v234
    v_mfma_f32_16x16x32_bf16 v[60:63], v[212:215], a[160:163], 0
    ds_read_b128 a[116:119], v225 offset:2048
    v_fma_f32 v197, v197, s29, -v234
    v_mfma_f32_16x16x32_bf16 v[64:67], v[212:215], a[164:167], 0
    s_addc_u32 s40, s40, 0
    v_exp_f32 v187, v187
    v_mfma_f32_16x16x32_bf16 v[68:71], v[212:215], a[168:171], 0
    s_mul_i32 s40, s40, s44
    s_add_u32 s43, s43, s40
    s_add_u32 s43, s43, 135168
    s_cmp_lt_u32 s24, 2
    s_cselect_b64 s[84:85], s[6:7], s[54:55]
    s_add_u32 s84, s84, s43
    s_addc_u32 s85, s85, 0
    s_cmp_eq_u32 s31, 1
    s_cselect_b32 s86, s44, 0
    s_mov_b32 s0, 12288
    s_mov_b32 s1, 2
    v_mfma_f32_16x16x32_bf16 v[72:75], v[212:215], a[172:175], 0
    ds_read_b128 a[120:123], v224 offset:6144
    ds_write_b128 v246, v[168:171] offset:20992
    v_mfma_f32_16x16x32_bf16 v[76:79], v[212:215], a[176:179], 0
    s_add_u32 m0, s35, 0
    v_exp_f32 v188, v188
    v_mfma_f32_16x16x32_bf16 v[80:83], v[212:215], a[180:183], 0
    buffer_load_dwordx4 v230, s[16:19], 0 offen offset:0 nt lds
    v_add_f32 v236, v236, v176
    v_mfma_f32_16x16x32_bf16 v[84:87], v[212:215], a[184:187], 0
    s_add_u32 s12, s12, 12288
    v_add_f32 v236, v236, v177
    v_cvt_pk_bf16_f32 v208, v176, v177
    v_mfma_f32_16x16x32_bf16 a[196:199], v[212:215], a[188:191], 0
    s_addc_u32 s13, s13, 0
    v_exp_f32 v189, v189
    v_mfma_f32_16x16x32_bf16 v[88:91], v[216:219], a[144:147], 0
    ds_read_b128 a[124:127], v225 offset:6144
    v_add_f32 v236, v236, v178
    v_mfma_f32_16x16x32_bf16 v[92:95], v[216:219], a[148:151], 0
    ds_read_b128 a[128:131], v224 offset:7168
    v_add_f32 v236, v236, v179
    v_mfma_f32_16x16x32_bf16 v[96:99], v[216:219], a[152:155], 0
    s_add_u32 m0, s35, 896
    v_exp_f32 v190, v190
    v_mfma_f32_16x16x32_bf16 v[100:103], v[216:219], a[156:159], 0
    buffer_load_dwordx4 v230, s[16:19], 0 offen offset:128 nt lds
    v_cvt_pk_bf16_f32 v209, v178, v179
    v_mfma_f32_16x16x32_bf16 v[104:107], v[216:219], a[160:163], 0
    v_add_f32 v236, v236, v180
    v_add_f32 v236, v236, v181
    v_mfma_f32_16x16x32_bf16 v[108:111], v[216:219], a[164:167], 0
    v_exp_f32 v191, v191
    v_mfma_f32_16x16x32_bf16 v[112:115], v[216:219], a[168:171], 0
    ds_read_b128 a[132:135], v225 offset:7168
    v_cvt_pk_bf16_f32 v210, v180, v181
    v_mfma_f32_16x16x32_bf16 v[116:119], v[216:219], a[172:175], 0
    ds_read_b128 a[136:139], v224 offset:8192
    v_add_f32 v236, v236, v182
    v_mfma_f32_16x16x32_bf16 v[120:123], v[216:219], a[176:179], 0
    s_add_u32 m0, s35, 1792
    v_exp_f32 v192, v192
    v_mfma_f32_16x16x32_bf16 v[124:127], v[216:219], a[180:183], 0
    buffer_load_dwordx4 v230, s[16:19], 0 offen offset:256 nt lds
    v_add_f32 v236, v236, v183
    v_mfma_f32_16x16x32_bf16 v[128:131], v[216:219], a[184:187], 0
    s_add_u32 s16, s16, 3072
    v_cvt_pk_bf16_f32 v211, v182, v183
    v_add_f32 v237, v237, v184
    v_mfma_f32_16x16x32_bf16 a[200:203], v[216:219], a[188:191], 0
    s_addc_u32 s17, s17, 0
    v_exp_f32 v193, v193
    v_mfma_f32_16x16x32_bf16 v[132:135], v[220:223], a[144:147], 0
    ds_read_b128 a[140:143], v225 offset:8192
    v_add_f32 v237, v237, v185
    v_mfma_f32_16x16x32_bf16 v[136:139], v[220:223], a[148:151], 0
    s_add_u32 s35, s35, 3072
    v_cvt_pk_bf16_f32 v212, v184, v185
    v_add_f32 v237, v237, v186
    v_mfma_f32_16x16x32_bf16 v[140:143], v[220:223], a[152:155], 0
    s_add_u32 s28, s28, 3072
    v_exp_f32 v194, v194
    v_mfma_f32_16x16x32_bf16 v[144:147], v[220:223], a[156:159], 0
    v_add_f32 v237, v237, v187
    v_cvt_pk_bf16_f32 v213, v186, v187
    v_mfma_f32_16x16x32_bf16 v[148:151], v[220:223], a[160:163], 0
    v_add_f32 v237, v237, v188
    v_add_f32 v237, v237, v189
    v_mfma_f32_16x16x32_bf16 v[152:155], v[220:223], a[164:167], 0
    v_exp_f32 v195, v195
    v_mfma_f32_16x16x32_bf16 v[156:159], v[220:223], a[168:171], 0
    v_cvt_pk_bf16_f32 v214, v188, v189
    v_add_f32 v237, v237, v190
    v_mfma_f32_16x16x32_bf16 v[160:163], v[220:223], a[172:175], 0
    v_add_f32 v237, v237, v191
    v_cvt_pk_bf16_f32 v215, v190, v191
    v_mfma_f32_16x16x32_bf16 v[164:167], v[220:223], a[176:179], 0
    v_exp_f32 v196, v196
    v_mfma_f32_16x16x32_bf16 v[168:171], v[220:223], a[180:183], 0
    v_add_f32 v238, v238, v192
    v_add_f32 v238, v238, v193
    v_mfma_f32_16x16x32_bf16 v[172:175], v[220:223], a[184:187], 0
    v_cvt_pk_bf16_f32 v216, v192, v193
    v_add_f32 v238, v238, v194
    v_mfma_f32_16x16x32_bf16 a[204:207], v[220:223], a[188:191], 0
    s_waitcnt vmcnt(16) lgkmcnt(0)
    v_exp_f32 v197, v197
    v_add_f32 v238, v238, v195
    v_cvt_pk_bf16_f32 v217, v194, v195
    v_fma_f32 v198, v198, s29, -v234
    v_fma_f32 v199, v199, s29, -v234
    v_fma_f32 v200, v200, s29, -v235
    v_fma_f32 v201, v201, s29, -v235
    v_fma_f32 v202, v202, s29, -v235
    v_fma_f32 v203, v203, s29, -v235
    v_fma_f32 v204, v204, s29, -v235
    v_fma_f32 v205, v205, s29, -v235
    v_fma_f32 v206, v206, s29, -v235
    v_fma_f32 v207, v207, s29, -v235
    v_add_u32 v231, 3072, v231
    s_branch L_O
.p2align 6
L_T:
    v_mfma_f32_16x16x32_bf16 v[176:179], a[96:99], a[0:3], 0
    s_barrier
    v_mfma_f32_16x16x32_bf16 v[176:179], a[100:103], a[4:7], v[176:179]
    ds_read_b64_tr_b16 a[144:145], v226 offset:24576
    ds_read_b64_tr_b16 a[146:147], v226 offset:30720
    v_mfma_f32_16x16x32_bf16 v[176:179], a[104:107], a[8:11], v[176:179]
    ds_read_b64_tr_b16 a[148:149], v227 offset:24576
    ds_read_b64_tr_b16 a[150:151], v227 offset:30720
    v_mfma_f32_16x16x32_bf16 v[176:179], a[108:111], a[12:15], v[176:179]
    ds_read_b64_tr_b16 a[152:153], v228 offset:24576
    ds_read_b64_tr_b16 a[154:155], v228 offset:30720
    v_mfma_f32_16x16x32_bf16 v[176:179], a[112:115], a[16:19], v[176:179]
    ds_read_b64_tr_b16 a[156:157], v229 offset:24576
    ds_read_b64_tr_b16 a[158:159], v229 offset:30720
    v_mfma_f32_16x16x32_bf16 v[176:179], a[116:119], a[20:23], v[176:179]
    ds_read_b64_tr_b16 a[160:161], v226 offset:25600
    ds_read_b64_tr_b16 a[162:163], v226 offset:31744
    v_mfma_f32_16x16x32_bf16 v[180:183], a[120:123], a[0:3], 0
    ds_read_b64_tr_b16 a[164:165], v227 offset:25600
    ds_read_b64_tr_b16 a[166:167], v227 offset:31744
    v_mfma_f32_16x16x32_bf16 v[180:183], a[124:127], a[4:7], v[180:183]
    ds_read_b64_tr_b16 a[168:169], v228 offset:25600
    ds_read_b64_tr_b16 a[170:171], v228 offset:31744
    v_mfma_f32_16x16x32_bf16 v[180:183], a[128:131], a[8:11], v[180:183]
    ds_read_b64_tr_b16 a[172:173], v229 offset:25600
    ds_read_b64_tr_b16 a[174:175], v229 offset:31744
    v_mfma_f32_16x16x32_bf16 v[180:183], a[132:135], a[12:15], v[180:183]
    ds_read_b64_tr_b16 a[176:177], v226 offset:26624
    ds_read_b64_tr_b16 a[178:179], v226 offset:32768
    v_mfma_f32_16x16x32_bf16 v[180:183], a[136:139], a[16:19], v[180:183]
    ds_read_b64_tr_b16 a[180:181], v227 offset:26624
    ds_read_b64_tr_b16 a[182:183], v227 offset:32768
    v_mfma_f32_16x16x32_bf16 v[180:183], a[140:143], a[20:23], v[180:183]
    ds_read_b64_tr_b16 a[184:185], v228 offset:26624
    ds_read_b64_tr_b16 a[186:187], v228 offset:32768
    s_waitcnt lgkmcnt(15)
    v_mfma_f32_16x16x32_bf16 v[0:3], v[208:211], a[144:147], v[0:3]
    ds_read_b64_tr_b16 a[188:189], v229 offset:26624
    ds_read_b64_tr_b16 a[190:191], v229 offset:32768
    v_mfma_f32_16x16x32_bf16 v[4:7], v[208:211], a[148:151], v[4:7]
    s_waitcnt vmcnt(0)
    v_fma_f32 v176, v176, s29, -v232
    v_fma_f32 v177, v177, s29, -v232
    v_mfma_f32_16x16x32_bf16 v[8:11], v[208:211], a[152:155], v[8:11]
    s_waitcnt lgkmcnt(12)
    s_barrier
    v_mfma_f32_16x16x32_bf16 v[12:15], v[208:211], a[156:159], v[12:15]
    buffer_store_dwordx4 a[208:211], v247, s[20:23], s28 offen offset:0 sc1
    v_fma_f32 v178, v178, s29, -v232
    v_fma_f32 v179, v179, s29, -v232
    v_fma_f32 v180, v180, s29, -v232
    v_fma_f32 v181, v181, s29, -v232
    v_mfma_f32_16x16x32_bf16 v[16:19], v[208:211], a[160:163], v[16:19]
    ds_read_b64_tr_b16 a[220:221], v226 offset:36864
    ds_read_b64_tr_b16 a[222:223], v226 offset:43008
    v_mfma_f32_16x16x32_bf16 v[20:23], v[208:211], a[164:167], v[20:23]
    s_waitcnt lgkmcnt(8)
    v_fma_f32 v182, v182, s29, -v232
    v_fma_f32 v183, v183, s29, -v232
    v_mfma_f32_16x16x32_bf16 v[24:27], v[208:211], a[168:171], v[24:27]
    ds_read_b64_tr_b16 a[224:225], v227 offset:36864
    ds_read_b64_tr_b16 a[226:227], v227 offset:43008
    v_mfma_f32_16x16x32_bf16 v[28:31], v[208:211], a[172:175], v[28:31]
    s_mul_i32 s39, s32, 98304
    v_exp_f32 v176, v176
    v_mfma_f32_16x16x32_bf16 v[32:35], v[208:211], a[176:179], v[32:35]
    s_waitcnt lgkmcnt(4)
    v_exp_f32 v177, v177
    v_mfma_f32_16x16x32_bf16 v[36:39], v[208:211], a[180:183], v[36:39]
    ds_read_b64_tr_b16 a[228:229], v228 offset:36864
    ds_read_b64_tr_b16 a[230:231], v228 offset:43008
    v_mfma_f32_16x16x32_bf16 v[40:43], v[208:211], a[184:187], v[40:43]
    buffer_store_dwordx4 a[212:215], v247, s[20:23], s28 offen offset:128 sc1
    v_exp_f32 v178, v178
    v_exp_f32 v179, v179
    v_mfma_f32_16x16x32_bf16 a[192:195], v[208:211], a[188:191], a[192:195]
    ds_read_b64_tr_b16 a[232:233], v229 offset:36864
    ds_read_b64_tr_b16 a[234:235], v229 offset:43008
    v_mfma_f32_16x16x32_bf16 v[184:187], a[96:99], a[24:27], 0
    s_mul_i32 s40, s24, 24576
    v_exp_f32 v180, v180
    v_mfma_f32_16x16x32_bf16 v[184:187], a[100:103], a[28:31], v[184:187]
    ds_read_b64_tr_b16 a[236:237], v226 offset:37888
    ds_read_b64_tr_b16 a[238:239], v226 offset:44032
    v_mfma_f32_16x16x32_bf16 v[184:187], a[104:107], a[32:35], v[184:187]
    s_add_u32 s39, s39, s40
    v_exp_f32 v181, v181
    v_mfma_f32_16x16x32_bf16 v[184:187], a[108:111], a[36:39], v[184:187]
    ds_read_b64_tr_b16 a[240:241], v227 offset:37888
    ds_read_b64_tr_b16 a[242:243], v227 offset:44032
    v_mfma_f32_16x16x32_bf16 v[184:187], a[112:115], a[40:43], v[184:187]
    v_exp_f32 v182, v182
    v_mfma_f32_16x16x32_bf16 v[184:187], a[116:119], a[44:47], v[184:187]
    buffer_store_dwordx4 a[216:219], v247, s[20:23], s28 offen offset:256 sc1
    v_exp_f32 v183, v183
    v_add_f32 v236, v236, v176
    v_add_f32 v236, v236, v177
    v_mfma_f32_16x16x32_bf16 v[188:191], a[120:123], a[24:27], 0
    ds_read_b64_tr_b16 a[244:245], v228 offset:37888
    ds_read_b64_tr_b16 a[246:247], v228 offset:44032
    v_mfma_f32_16x16x32_bf16 v[188:191], a[124:127], a[28:31], v[188:191]
    s_add_u32 s20, s48, s39
    v_add_f32 v236, v236, v178
    v_add_f32 v236, v236, v179
    v_mfma_f32_16x16x32_bf16 v[188:191], a[128:131], a[32:35], v[188:191]
    ds_read_b64_tr_b16 a[248:249], v229 offset:37888
    ds_read_b64_tr_b16 a[250:251], v229 offset:44032
    v_mfma_f32_16x16x32_bf16 v[188:191], a[132:135], a[36:39], v[188:191]
    s_addc_u32 s21, s49, 0
    v_add_f32 v236, v236, v180
    v_add_f32 v236, v236, v181
    v_add_f32 v236, v236, v182
    v_add_f32 v236, v236, v183
    v_mfma_f32_16x16x32_bf16 v[188:191], a[136:139], a[40:43], v[188:191]
    ds_read_b64_tr_b16 a[252:253], v226 offset:38912
    ds_read_b64_tr_b16 a[254:255], v226 offset:45056
    s_mov_b32 s22, 24576
    v_cvt_pk_bf16_f32 v176, v176, v177
    v_cvt_pk_bf16_f32 v177, v178, v179
    v_cvt_pk_bf16_f32 v178, v180, v181
    v_cvt_pk_bf16_f32 v179, v182, v183
    v_mov_b32 v240, v236
    v_mfma_f32_16x16x32_bf16 v[188:191], a[140:143], a[44:47], v[188:191]
    s_waitcnt lgkmcnt(12)
    v_mov_b32 v231, v250
    v_fma_f32 v184, v184, s29, -v233
    v_mfma_f32_16x16x32_bf16 v[0:3], v[176:179], a[220:223], v[0:3]
    ds_read_b64_tr_b16 a[0:1], v227 offset:38912
    ds_read_b64_tr_b16 a[2:3], v227 offset:45056
    v_permlane32_swap_b32 v240, v236
    v_mfma_f32_16x16x32_bf16 v[4:7], v[176:179], a[224:227], v[4:7]
    s_mov_b32 s42, 0x53800000
    v_add_f32 v240, v240, v236
    v_fma_f32 v185, v185, s29, -v233
    v_mfma_f32_16x16x32_bf16 v[8:11], v[176:179], a[228:231], v[8:11]
    ds_read_b64_tr_b16 a[4:5], v228 offset:38912
    ds_read_b64_tr_b16 a[6:7], v228 offset:45056
    s_waitcnt lgkmcnt(10)
    v_mov_b32 v236, v240
    v_mfma_f32_16x16x32_bf16 v[12:15], v[176:179], a[232:235], v[12:15]
    v_fma_f32 v186, v186, s29, -v233
    v_fma_f32 v187, v187, s29, -v233
    v_mfma_f32_16x16x32_bf16 v[16:19], v[176:179], a[236:239], v[16:19]
    ds_read_b64_tr_b16 a[8:9], v229 offset:38912
    ds_read_b64_tr_b16 a[10:11], v229 offset:45056
    v_permlane16_swap_b32 v240, v236
    v_mfma_f32_16x16x32_bf16 v[20:23], v[176:179], a[240:243], v[20:23]
    s_waitcnt lgkmcnt(6)
    v_add_f32 v236, v240, v236
    v_fma_f32 v188, v188, s29, -v233
    v_mfma_f32_16x16x32_bf16 v[24:27], v[176:179], a[244:247], v[24:27]
    v_rcp_f32 v240, v236
    v_mfma_f32_16x16x32_bf16 v[28:31], v[176:179], a[248:251], v[28:31]
    ds_write_b32 v248, v240 offset:0
    v_mfma_f32_16x16x32_bf16 v[32:35], v[176:179], a[252:255], v[32:35]
    ds_read_b128 v[180:183], v249 offset:0
    s_waitcnt lgkmcnt(2)
    v_mfma_f32_16x16x32_bf16 v[36:39], v[176:179], a[0:3], v[36:39]
    v_cmp_nge_f32 vcc, s42, v236
    v_fma_f32 v189, v189, s29, -v233
    v_mfma_f32_16x16x32_bf16 v[40:43], v[176:179], a[4:7], v[40:43]
    s_cmp_lg_u64 vcc, 0
    v_fma_f32 v190, v190, s29, -v233
    v_fma_f32 v191, v191, s29, -v233
    v_mfma_f32_16x16x32_bf16 a[192:195], v[176:179], a[8:11], a[192:195]
    s_cselect_b32 s42, 1, 0
    v_exp_f32 v184, v184
    v_mfma_f32_16x16x32_bf16 v[44:47], v[212:215], a[144:147], v[44:47]
    s_lshl_b32 s42, s42, s51
    v_exp_f32 v185, v185
    s_waitcnt lgkmcnt(0)
.p2align 3
    v_pk_mul_f32 v[0:1], v[0:1], v[180:181]
    v_pk_mul_f32 v[242:243], v[2:3], v[182:183]
    v_pk_mul_f32 v[2:3], v[4:5], v[180:181]
    v_pk_mul_f32 v[8:9], v[8:9], v[180:181]
    v_pk_mul_f32 v[12:13], v[12:13], v[180:181]
    v_cvt_pk_bf16_f32 v0, v0, v2
    v_cvt_pk_bf16_f32 v2, v1, v3
    v_cvt_pk_bf16_f32 v1, v8, v12
    v_cvt_pk_bf16_f32 v3, v9, v13
    ds_write_b128 v246, v[0:3] offset:0
    v_pk_mul_f32 v[6:7], v[6:7], v[182:183]
    v_pk_mul_f32 v[10:11], v[10:11], v[182:183]
    v_pk_mul_f32 v[14:15], v[14:15], v[182:183]
    v_cvt_pk_bf16_f32 v4, v242, v6
    v_cvt_pk_bf16_f32 v6, v243, v7
    v_cvt_pk_bf16_f32 v5, v10, v14
    v_cvt_pk_bf16_f32 v7, v11, v15
    ds_write_b128 v246, v[4:7] offset:512
    ds_read_b64_tr_b16 a[24:25], v231 offset:0
    ds_read_b64_tr_b16 a[26:27], v231 offset:64
    ds_read_b64_tr_b16 a[36:37], v231 offset:3072
    ds_read_b64_tr_b16 a[38:39], v231 offset:3136
    v_pk_mul_f32 v[16:17], v[16:17], v[180:181]
    v_pk_mul_f32 v[242:243], v[18:19], v[182:183]
    v_pk_mul_f32 v[18:19], v[20:21], v[180:181]
    v_pk_mul_f32 v[24:25], v[24:25], v[180:181]
    v_pk_mul_f32 v[28:29], v[28:29], v[180:181]
    v_cvt_pk_bf16_f32 v16, v16, v18
    v_cvt_pk_bf16_f32 v18, v17, v19
    v_cvt_pk_bf16_f32 v17, v24, v28
    v_cvt_pk_bf16_f32 v19, v25, v29
    ds_write_b128 v246, v[16:19] offset:1024
    s_waitcnt lgkmcnt(1)
    s_mov_b32 s28, 0
    buffer_store_dwordx4 a[24:27], v247, s[20:23], s28 offen offset:0 sc1
    buffer_store_dwordx4 a[36:39], v247, s[20:23], s28 offen offset:3072 sc1
.p2align 3
    v_pk_mul_f32 v[22:23], v[22:23], v[182:183]
    v_pk_mul_f32 v[26:27], v[26:27], v[182:183]
    v_pk_mul_f32 v[30:31], v[30:31], v[182:183]
    v_cvt_pk_bf16_f32 v20, v242, v22
    v_cvt_pk_bf16_f32 v22, v243, v23
    v_cvt_pk_bf16_f32 v21, v26, v30
    v_cvt_pk_bf16_f32 v23, v27, v31
    ds_write_b128 v246, v[20:23] offset:1536
    ds_read_b64_tr_b16 a[28:29], v231 offset:1024
    ds_read_b64_tr_b16 a[30:31], v231 offset:1088
    ds_read_b64_tr_b16 a[40:41], v231 offset:4096
    ds_read_b64_tr_b16 a[42:43], v231 offset:4160
    v_accvgpr_read_b32 v28, a192
    v_accvgpr_read_b32 v29, a193
    v_accvgpr_read_b32 v30, a194
    v_accvgpr_read_b32 v31, a195
    v_pk_mul_f32 v[32:33], v[32:33], v[180:181]
    v_pk_mul_f32 v[242:243], v[34:35], v[182:183]
    v_pk_mul_f32 v[34:35], v[36:37], v[180:181]
    v_pk_mul_f32 v[40:41], v[40:41], v[180:181]
    v_pk_mul_f32 v[28:29], v[28:29], v[180:181]
    v_cvt_pk_bf16_f32 v32, v32, v34
    v_cvt_pk_bf16_f32 v34, v33, v35
    v_cvt_pk_bf16_f32 v33, v40, v28
    v_cvt_pk_bf16_f32 v35, v41, v29
    ds_write_b128 v246, v[32:35] offset:2048
    s_waitcnt lgkmcnt(1)
    buffer_store_dwordx4 a[28:31], v247, s[20:23], s28 offen offset:128 sc1
    buffer_store_dwordx4 a[40:43], v247, s[20:23], s28 offen offset:3200 sc1
.p2align 3
    v_pk_mul_f32 v[38:39], v[38:39], v[182:183]
    v_pk_mul_f32 v[42:43], v[42:43], v[182:183]
    v_pk_mul_f32 v[30:31], v[30:31], v[182:183]
    v_cvt_pk_bf16_f32 v36, v242, v38
    v_cvt_pk_bf16_f32 v38, v243, v39
    v_cvt_pk_bf16_f32 v37, v42, v30
    v_cvt_pk_bf16_f32 v39, v43, v31
    ds_write_b128 v246, v[36:39] offset:2560
    ds_read_b64_tr_b16 a[32:33], v231 offset:2048
    ds_read_b64_tr_b16 a[34:35], v231 offset:2112
    ds_read_b64_tr_b16 a[44:45], v231 offset:5120
    ds_read_b64_tr_b16 a[46:47], v231 offset:5184
    v_mfma_f32_16x16x32_bf16 v[48:51], v[212:215], a[148:151], v[48:51]
    s_or_b32 s36, s36, s42
    v_exp_f32 v186, v186
    v_mfma_f32_16x16x32_bf16 v[52:55], v[212:215], a[152:155], v[52:55]
    v_exp_f32 v187, v187
    v_mfma_f32_16x16x32_bf16 v[56:59], v[212:215], a[156:159], v[56:59]
    v_exp_f32 v188, v188
    v_mfma_f32_16x16x32_bf16 v[60:63], v[212:215], a[160:163], v[60:63]
    s_waitcnt lgkmcnt(0)
    v_exp_f32 v189, v189
    v_mfma_f32_16x16x32_bf16 v[64:67], v[212:215], a[164:167], v[64:67]
    buffer_store_dwordx4 a[32:35], v247, s[20:23], s28 offen offset:256 sc1
    v_exp_f32 v190, v190
    v_exp_f32 v191, v191
    v_mfma_f32_16x16x32_bf16 v[68:71], v[212:215], a[168:171], v[68:71]
    v_add_f32 v237, v237, v184
    v_add_f32 v237, v237, v185
    v_mfma_f32_16x16x32_bf16 v[72:75], v[212:215], a[172:175], v[72:75]
    v_add_f32 v237, v237, v186
    v_add_f32 v237, v237, v187
    v_mfma_f32_16x16x32_bf16 v[76:79], v[212:215], a[176:179], v[76:79]
    buffer_store_dwordx4 a[44:47], v247, s[20:23], s28 offen offset:3328 sc1
    v_add_f32 v237, v237, v188
    v_add_f32 v237, v237, v189
    v_add_f32 v237, v237, v190
    v_add_f32 v237, v237, v191
    v_mfma_f32_16x16x32_bf16 v[80:83], v[212:215], a[180:183], v[80:83]
    v_cvt_pk_bf16_f32 v184, v184, v185
    v_cvt_pk_bf16_f32 v185, v186, v187
    v_mfma_f32_16x16x32_bf16 v[84:87], v[212:215], a[184:187], v[84:87]
    v_cvt_pk_bf16_f32 v186, v188, v189
    v_cvt_pk_bf16_f32 v187, v190, v191
    v_mov_b32 v241, v237
    v_mfma_f32_16x16x32_bf16 a[196:199], v[212:215], a[188:191], a[196:199]
    s_mov_b32 s42, 0x53800000
    v_exp_f32 v198, v198
    v_mfma_f32_16x16x32_bf16 v[44:47], v[184:187], a[220:223], v[44:47]
    v_permlane32_swap_b32 v241, v237
    v_mfma_f32_16x16x32_bf16 v[48:51], v[184:187], a[224:227], v[48:51]
    v_add_f32 v241, v241, v237
    v_add_f32 v238, v238, v196
    v_mfma_f32_16x16x32_bf16 v[52:55], v[184:187], a[228:231], v[52:55]
    v_mov_b32 v237, v241
    v_add_f32 v238, v238, v197
    v_mfma_f32_16x16x32_bf16 v[56:59], v[184:187], a[232:235], v[56:59]
    v_exp_f32 v199, v199
    v_mfma_f32_16x16x32_bf16 v[60:63], v[184:187], a[236:239], v[60:63]
    v_permlane16_swap_b32 v241, v237
    v_mfma_f32_16x16x32_bf16 v[64:67], v[184:187], a[240:243], v[64:67]
    v_add_f32 v237, v241, v237
    v_cvt_pk_bf16_f32 v218, v196, v197
    v_mfma_f32_16x16x32_bf16 v[68:71], v[184:187], a[244:247], v[68:71]
    v_rcp_f32 v241, v237
    v_mfma_f32_16x16x32_bf16 v[72:75], v[184:187], a[248:251], v[72:75]
    ds_write_b32 v248, v241 offset:0
    v_mfma_f32_16x16x32_bf16 v[76:79], v[184:187], a[252:255], v[76:79]
    ds_read_b128 v[188:191], v249 offset:0
    v_cmp_nge_f32 vcc, s42, v237
    v_mfma_f32_16x16x32_bf16 v[80:83], v[184:187], a[0:3], v[80:83]
    v_add_f32 v238, v238, v198
    v_add_f32 v238, v238, v199
    v_mfma_f32_16x16x32_bf16 v[84:87], v[184:187], a[4:7], v[84:87]
    s_cmp_lg_u64 vcc, 0
    v_cvt_pk_bf16_f32 v219, v198, v199
    v_mfma_f32_16x16x32_bf16 a[196:199], v[184:187], a[8:11], a[196:199]
    s_cselect_b32 s42, 1, 0
    v_exp_f32 v200, v200
    v_mfma_f32_16x16x32_bf16 v[192:195], a[96:99], a[48:51], 0
    s_lshl_b32 s42, s42, s51
    v_exp_f32 v201, v201
    v_mfma_f32_16x16x32_bf16 v[192:195], a[100:103], a[52:55], v[192:195]
    s_or_b32 s36, s36, s42
    v_exp_f32 v202, v202
    v_mfma_f32_16x16x32_bf16 v[192:195], a[104:107], a[56:59], v[192:195]
    v_exp_f32 v203, v203
    s_waitcnt lgkmcnt(0)
.p2align 3
    v_pk_mul_f32 v[44:45], v[44:45], v[188:189]
    v_pk_mul_f32 v[242:243], v[46:47], v[190:191]
    v_pk_mul_f32 v[46:47], v[48:49], v[188:189]
    v_pk_mul_f32 v[52:53], v[52:53], v[188:189]
    v_pk_mul_f32 v[56:57], v[56:57], v[188:189]
    v_cvt_pk_bf16_f32 v44, v44, v46
    v_cvt_pk_bf16_f32 v46, v45, v47
    v_cvt_pk_bf16_f32 v45, v52, v56
    v_cvt_pk_bf16_f32 v47, v53, v57
    ds_write_b128 v246, v[44:47] offset:6144
    v_pk_mul_f32 v[50:51], v[50:51], v[190:191]
    v_pk_mul_f32 v[54:55], v[54:55], v[190:191]
    v_pk_mul_f32 v[58:59], v[58:59], v[190:191]
    v_cvt_pk_bf16_f32 v48, v242, v50
    v_cvt_pk_bf16_f32 v50, v243, v51
    v_cvt_pk_bf16_f32 v49, v54, v58
    v_cvt_pk_bf16_f32 v51, v55, v59
    ds_write_b128 v246, v[48:51] offset:6656
    ds_read_b64_tr_b16 a[12:13], v231 offset:6144
    ds_read_b64_tr_b16 a[14:15], v231 offset:6208
    ds_read_b64_tr_b16 a[208:209], v231 offset:9216
    ds_read_b64_tr_b16 a[210:211], v231 offset:9280
    v_pk_mul_f32 v[60:61], v[60:61], v[188:189]
    v_pk_mul_f32 v[242:243], v[62:63], v[190:191]
    v_pk_mul_f32 v[62:63], v[64:65], v[188:189]
    v_pk_mul_f32 v[68:69], v[68:69], v[188:189]
    v_pk_mul_f32 v[72:73], v[72:73], v[188:189]
    v_cvt_pk_bf16_f32 v60, v60, v62
    v_cvt_pk_bf16_f32 v62, v61, v63
    v_cvt_pk_bf16_f32 v61, v68, v72
    v_cvt_pk_bf16_f32 v63, v69, v73
    ds_write_b128 v246, v[60:63] offset:7168
    v_pk_mul_f32 v[66:67], v[66:67], v[190:191]
    v_pk_mul_f32 v[70:71], v[70:71], v[190:191]
    v_pk_mul_f32 v[74:75], v[74:75], v[190:191]
    v_cvt_pk_bf16_f32 v64, v242, v66
    v_cvt_pk_bf16_f32 v66, v243, v67
    v_cvt_pk_bf16_f32 v65, v70, v74
    v_cvt_pk_bf16_f32 v67, v71, v75
    ds_write_b128 v246, v[64:67] offset:7680
    ds_read_b64_tr_b16 a[16:17], v231 offset:7168
    ds_read_b64_tr_b16 a[18:19], v231 offset:7232
    ds_read_b64_tr_b16 a[212:213], v231 offset:10240
    ds_read_b64_tr_b16 a[214:215], v231 offset:10304
    v_accvgpr_read_b32 v72, a196
    v_accvgpr_read_b32 v73, a197
    v_accvgpr_read_b32 v74, a198
    v_accvgpr_read_b32 v75, a199
    v_pk_mul_f32 v[76:77], v[76:77], v[188:189]
    v_pk_mul_f32 v[242:243], v[78:79], v[190:191]
    v_pk_mul_f32 v[78:79], v[80:81], v[188:189]
    v_pk_mul_f32 v[84:85], v[84:85], v[188:189]
    v_pk_mul_f32 v[72:73], v[72:73], v[188:189]
    v_cvt_pk_bf16_f32 v76, v76, v78
    v_cvt_pk_bf16_f32 v78, v77, v79
    v_cvt_pk_bf16_f32 v77, v84, v72
    v_cvt_pk_bf16_f32 v79, v85, v73
    ds_write_b128 v246, v[76:79] offset:8192
    v_pk_mul_f32 v[82:83], v[82:83], v[190:191]
    v_pk_mul_f32 v[86:87], v[86:87], v[190:191]
    v_pk_mul_f32 v[74:75], v[74:75], v[190:191]
    v_cvt_pk_bf16_f32 v80, v242, v82
    v_cvt_pk_bf16_f32 v82, v243, v83
    v_cvt_pk_bf16_f32 v81, v86, v74
    v_cvt_pk_bf16_f32 v83, v87, v75
    ds_write_b128 v246, v[80:83] offset:8704
    ds_read_b64_tr_b16 a[20:21], v231 offset:8192
    ds_read_b64_tr_b16 a[22:23], v231 offset:8256
    ds_read_b64_tr_b16 a[216:217], v231 offset:11264
    ds_read_b64_tr_b16 a[218:219], v231 offset:11328
    v_mfma_f32_16x16x32_bf16 v[192:195], a[108:111], a[60:63], v[192:195]
    v_exp_f32 v204, v204
    v_mfma_f32_16x16x32_bf16 v[192:195], a[112:115], a[64:67], v[192:195]
    v_exp_f32 v205, v205
    v_mfma_f32_16x16x32_bf16 v[192:195], a[116:119], a[68:71], v[192:195]
    v_exp_f32 v206, v206
    v_mfma_f32_16x16x32_bf16 v[196:199], a[120:123], a[48:51], 0
    s_waitcnt lgkmcnt(12)
    s_mov_b32 s28, 6144
    v_add_f32 v239, v239, v200
    v_mfma_f32_16x16x32_bf16 v[196:199], a[124:127], a[52:55], v[196:199]
    buffer_store_dwordx4 a[12:15], v247, s[20:23], s28 offen offset:0 sc1
    v_exp_f32 v207, v207
    v_add_f32 v239, v239, v201
    v_cvt_pk_bf16_f32 v220, v200, v201
    v_mfma_f32_16x16x32_bf16 v[196:199], a[128:131], a[56:59], v[196:199]
    v_add_f32 v239, v239, v202
    v_add_f32 v239, v239, v203
    v_mfma_f32_16x16x32_bf16 v[196:199], a[132:135], a[60:63], v[196:199]
    v_cvt_pk_bf16_f32 v221, v202, v203
    v_add_f32 v239, v239, v204
    v_mfma_f32_16x16x32_bf16 v[196:199], a[136:139], a[64:67], v[196:199]
    buffer_store_dwordx4 a[208:211], v247, s[20:23], s28 offen offset:3072 sc1
    v_add_f32 v239, v239, v205
    v_cvt_pk_bf16_f32 v222, v204, v205
    v_add_f32 v239, v239, v206
    v_add_f32 v239, v239, v207
    v_mfma_f32_16x16x32_bf16 v[196:199], a[140:143], a[68:71], v[196:199]
    v_cvt_pk_bf16_f32 v223, v206, v207
    v_fma_f32 v192, v192, s29, -v234
    v_mfma_f32_16x16x32_bf16 v[88:91], v[216:219], a[144:147], v[88:91]
    s_waitcnt lgkmcnt(6)
    v_fma_f32 v193, v193, s29, -v234
    v_fma_f32 v194, v194, s29, -v234
    v_mfma_f32_16x16x32_bf16 v[92:95], v[216:219], a[148:151], v[92:95]
    buffer_store_dwordx4 a[16:19], v247, s[20:23], s28 offen offset:128 sc1
    v_fma_f32 v195, v195, s29, -v234
    v_exp_f32 v192, v192
    v_mfma_f32_16x16x32_bf16 v[96:99], v[216:219], a[152:155], v[96:99]
    v_exp_f32 v193, v193
    v_mfma_f32_16x16x32_bf16 v[100:103], v[216:219], a[156:159], v[100:103]
    v_fma_f32 v196, v196, s29, -v234
    v_fma_f32 v197, v197, s29, -v234
    v_mfma_f32_16x16x32_bf16 v[104:107], v[216:219], a[160:163], v[104:107]
    buffer_store_dwordx4 a[212:215], v247, s[20:23], s28 offen offset:3200 sc1
    v_fma_f32 v198, v198, s29, -v234
    v_fma_f32 v199, v199, s29, -v234
    v_exp_f32 v194, v194
    v_mfma_f32_16x16x32_bf16 v[108:111], v[216:219], a[164:167], v[108:111]
    v_exp_f32 v195, v195
    v_mfma_f32_16x16x32_bf16 v[112:115], v[216:219], a[168:171], v[112:115]
    s_waitcnt lgkmcnt(0)
    v_exp_f32 v196, v196
    v_mfma_f32_16x16x32_bf16 v[116:119], v[216:219], a[172:175], v[116:119]
    buffer_store_dwordx4 a[20:23], v247, s[20:23], s28 offen offset:256 sc1
    v_exp_f32 v197, v197
    v_exp_f32 v198, v198
    v_mfma_f32_16x16x32_bf16 v[120:123], v[216:219], a[176:179], v[120:123]
    v_exp_f32 v199, v199
    v_mfma_f32_16x16x32_bf16 v[124:127], v[216:219], a[180:183], v[124:127]
    v_add_f32 v238, v238, v192
    v_add_f32 v238, v238, v193
    v_mfma_f32_16x16x32_bf16 v[128:131], v[216:219], a[184:187], v[128:131]
    buffer_store_dwordx4 a[216:219], v247, s[20:23], s28 offen offset:3328 sc1
    v_add_f32 v238, v238, v194
    v_add_f32 v238, v238, v195
    v_add_f32 v238, v238, v196
    v_add_f32 v238, v238, v197
    v_mfma_f32_16x16x32_bf16 a[200:203], v[216:219], a[188:191], a[200:203]
    v_add_f32 v238, v238, v198
    v_add_f32 v238, v238, v199
    v_mfma_f32_16x16x32_bf16 v[200:203], a[96:99], a[72:75], 0
    v_cvt_pk_bf16_f32 v192, v192, v193
    v_cvt_pk_bf16_f32 v193, v194, v195
    v_mfma_f32_16x16x32_bf16 v[200:203], a[100:103], a[76:79], v[200:203]
    v_cvt_pk_bf16_f32 v194, v196, v197
    v_cvt_pk_bf16_f32 v195, v198, v199
    v_mfma_f32_16x16x32_bf16 v[200:203], a[104:107], a[80:83], v[200:203]
    v_mov_b32 v240, v238
    v_mfma_f32_16x16x32_bf16 v[200:203], a[108:111], a[84:87], v[200:203]
    v_mfma_f32_16x16x32_bf16 v[200:203], a[112:115], a[88:91], v[200:203]
    v_permlane32_swap_b32 v240, v238
    v_mfma_f32_16x16x32_bf16 v[200:203], a[116:119], a[92:95], v[200:203]
    v_add_f32 v240, v240, v238
    v_mfma_f32_16x16x32_bf16 v[204:207], a[120:123], a[72:75], 0
    v_mov_b32 v238, v240
    v_mfma_f32_16x16x32_bf16 v[204:207], a[124:127], a[76:79], v[204:207]
    v_mfma_f32_16x16x32_bf16 v[204:207], a[128:131], a[80:83], v[204:207]
    v_permlane16_swap_b32 v240, v238
    v_mfma_f32_16x16x32_bf16 v[204:207], a[132:135], a[84:87], v[204:207]
    v_add_f32 v238, v240, v238
    v_fma_f32 v200, v200, s29, -v235
    v_mfma_f32_16x16x32_bf16 v[204:207], a[136:139], a[88:91], v[204:207]
    v_rcp_f32 v240, v238
    v_mfma_f32_16x16x32_bf16 v[204:207], a[140:143], a[92:95], v[204:207]
    s_mov_b32 s42, 0x53800000
    v_fma_f32 v201, v201, s29, -v235
    v_fma_f32 v202, v202, s29, -v235
    v_mfma_f32_16x16x32_bf16 v[88:91], v[192:195], a[220:223], v[88:91]
    v_fma_f32 v203, v203, s29, -v235
    v_mfma_f32_16x16x32_bf16 v[92:95], v[192:195], a[224:227], v[92:95]
    v_exp_f32 v200, v200
    v_mfma_f32_16x16x32_bf16 v[96:99], v[192:195], a[228:231], v[96:99]
    v_exp_f32 v201, v201
    v_mfma_f32_16x16x32_bf16 v[100:103], v[192:195], a[232:235], v[100:103]
    v_fma_f32 v204, v204, s29, -v235
    v_fma_f32 v205, v205, s29, -v235
    v_mfma_f32_16x16x32_bf16 v[104:107], v[192:195], a[236:239], v[104:107]
    v_fma_f32 v206, v206, s29, -v235
    v_fma_f32 v207, v207, s29, -v235
    v_mfma_f32_16x16x32_bf16 v[108:111], v[192:195], a[240:243], v[108:111]
    v_cmp_nge_f32 vcc, s42, v238
    v_add_f32 v239, v239, v200
    v_mfma_f32_16x16x32_bf16 v[112:115], v[192:195], a[244:247], v[112:115]
    v_exp_f32 v202, v202
    v_mfma_f32_16x16x32_bf16 v[116:119], v[192:195], a[248:251], v[116:119]
    ds_write_b32 v248, v240 offset:0
    v_mfma_f32_16x16x32_bf16 v[120:123], v[192:195], a[252:255], v[120:123]
    ds_read_b128 v[196:199], v249 offset:0
    v_add_f32 v239, v239, v201
    v_mfma_f32_16x16x32_bf16 v[124:127], v[192:195], a[0:3], v[124:127]
    v_exp_f32 v203, v203
    v_mfma_f32_16x16x32_bf16 v[128:131], v[192:195], a[4:7], v[128:131]
    s_cmp_lg_u64 vcc, 0
    v_exp_f32 v204, v204
    v_mfma_f32_16x16x32_bf16 a[200:203], v[192:195], a[8:11], a[200:203]
    s_cselect_b32 s42, 1, 0
    v_exp_f32 v205, v205
    v_mfma_f32_16x16x32_bf16 v[132:135], v[220:223], a[144:147], v[132:135]
    s_lshl_b32 s42, s42, s51
    v_exp_f32 v206, v206
    v_mfma_f32_16x16x32_bf16 v[136:139], v[220:223], a[148:151], v[136:139]
    s_or_b32 s36, s36, s42
    v_exp_f32 v207, v207
    v_mfma_f32_16x16x32_bf16 v[140:143], v[220:223], a[152:155], v[140:143]
    v_add_f32 v239, v239, v202
    v_add_f32 v239, v239, v203
    s_waitcnt lgkmcnt(0)
.p2align 3
    v_pk_mul_f32 v[88:89], v[88:89], v[196:197]
    v_pk_mul_f32 v[242:243], v[90:91], v[198:199]
    v_pk_mul_f32 v[90:91], v[92:93], v[196:197]
    v_pk_mul_f32 v[96:97], v[96:97], v[196:197]
    v_pk_mul_f32 v[100:101], v[100:101], v[196:197]
    v_cvt_pk_bf16_f32 v88, v88, v90
    v_cvt_pk_bf16_f32 v90, v89, v91
    v_cvt_pk_bf16_f32 v89, v96, v100
    v_cvt_pk_bf16_f32 v91, v97, v101
    ds_write_b128 v246, v[88:91] offset:12288
    v_pk_mul_f32 v[94:95], v[94:95], v[198:199]
    v_pk_mul_f32 v[98:99], v[98:99], v[198:199]
    v_pk_mul_f32 v[102:103], v[102:103], v[198:199]
    v_cvt_pk_bf16_f32 v92, v242, v94
    v_cvt_pk_bf16_f32 v94, v243, v95
    v_cvt_pk_bf16_f32 v93, v98, v102
    v_cvt_pk_bf16_f32 v95, v99, v103
    ds_write_b128 v246, v[92:95] offset:12800
    ds_read_b64_tr_b16 a[48:49], v231 offset:12288
    ds_read_b64_tr_b16 a[50:51], v231 offset:12352
    ds_read_b64_tr_b16 a[60:61], v231 offset:15360
    ds_read_b64_tr_b16 a[62:63], v231 offset:15424
    v_pk_mul_f32 v[104:105], v[104:105], v[196:197]
    v_pk_mul_f32 v[242:243], v[106:107], v[198:199]
    v_pk_mul_f32 v[106:107], v[108:109], v[196:197]
    v_pk_mul_f32 v[112:113], v[112:113], v[196:197]
    v_pk_mul_f32 v[116:117], v[116:117], v[196:197]
    v_cvt_pk_bf16_f32 v104, v104, v106
    v_cvt_pk_bf16_f32 v106, v105, v107
    v_cvt_pk_bf16_f32 v105, v112, v116
    v_cvt_pk_bf16_f32 v107, v113, v117
    ds_write_b128 v246, v[104:107] offset:13312
    v_pk_mul_f32 v[110:111], v[110:111], v[198:199]
    v_pk_mul_f32 v[114:115], v[114:115], v[198:199]
    v_pk_mul_f32 v[118:119], v[118:119], v[198:199]
    v_cvt_pk_bf16_f32 v108, v242, v110
    v_cvt_pk_bf16_f32 v110, v243, v111
    v_cvt_pk_bf16_f32 v109, v114, v118
    v_cvt_pk_bf16_f32 v111, v115, v119
    ds_write_b128 v246, v[108:111] offset:13824
    ds_read_b64_tr_b16 a[52:53], v231 offset:13312
    ds_read_b64_tr_b16 a[54:55], v231 offset:13376
    ds_read_b64_tr_b16 a[64:65], v231 offset:16384
    ds_read_b64_tr_b16 a[66:67], v231 offset:16448
    v_accvgpr_read_b32 v116, a200
    v_accvgpr_read_b32 v117, a201
    v_accvgpr_read_b32 v118, a202
    v_accvgpr_read_b32 v119, a203
    v_pk_mul_f32 v[120:121], v[120:121], v[196:197]
    v_pk_mul_f32 v[242:243], v[122:123], v[198:199]
    v_pk_mul_f32 v[122:123], v[124:125], v[196:197]
    v_pk_mul_f32 v[128:129], v[128:129], v[196:197]
    v_pk_mul_f32 v[116:117], v[116:117], v[196:197]
    v_cvt_pk_bf16_f32 v120, v120, v122
    v_cvt_pk_bf16_f32 v122, v121, v123
    v_cvt_pk_bf16_f32 v121, v128, v116
    v_cvt_pk_bf16_f32 v123, v129, v117
    ds_write_b128 v246, v[120:123] offset:14336
    v_pk_mul_f32 v[126:127], v[126:127], v[198:199]
    v_pk_mul_f32 v[130:131], v[130:131], v[198:199]
    v_pk_mul_f32 v[118:119], v[118:119], v[198:199]
    v_cvt_pk_bf16_f32 v124, v242, v126
    v_cvt_pk_bf16_f32 v126, v243, v127
    v_cvt_pk_bf16_f32 v125, v130, v118
    v_cvt_pk_bf16_f32 v127, v131, v119
    ds_write_b128 v246, v[124:127] offset:14848
    ds_read_b64_tr_b16 a[56:57], v231 offset:14336
    ds_read_b64_tr_b16 a[58:59], v231 offset:14400
    ds_read_b64_tr_b16 a[68:69], v231 offset:17408
    ds_read_b64_tr_b16 a[70:71], v231 offset:17472
    v_mfma_f32_16x16x32_bf16 v[144:147], v[220:223], a[156:159], v[144:147]
    v_add_f32 v239, v239, v204
    v_add_f32 v239, v239, v205
    v_mfma_f32_16x16x32_bf16 v[148:151], v[220:223], a[160:163], v[148:151]
    v_add_f32 v239, v239, v206
    v_add_f32 v239, v239, v207
    v_mfma_f32_16x16x32_bf16 v[152:155], v[220:223], a[164:167], v[152:155]
    v_cvt_pk_bf16_f32 v200, v200, v201
    v_cvt_pk_bf16_f32 v201, v202, v203
    v_mfma_f32_16x16x32_bf16 v[156:159], v[220:223], a[168:171], v[156:159]
    s_waitcnt lgkmcnt(12)
    s_mov_b32 s28, 12288
    v_cvt_pk_bf16_f32 v202, v204, v205
    v_mfma_f32_16x16x32_bf16 v[160:163], v[220:223], a[172:175], v[160:163]
    buffer_store_dwordx4 a[48:51], v247, s[20:23], s28 offen offset:0 sc1
    v_cvt_pk_bf16_f32 v203, v206, v207
    v_mov_b32 v241, v239
    v_mfma_f32_16x16x32_bf16 v[164:167], v[220:223], a[176:179], v[164:167]
    v_mfma_f32_16x16x32_bf16 v[168:171], v[220:223], a[180:183], v[168:171]
    v_permlane32_swap_b32 v241, v239
    v_mfma_f32_16x16x32_bf16 v[172:175], v[220:223], a[184:187], v[172:175]
    buffer_store_dwordx4 a[60:63], v247, s[20:23], s28 offen offset:3072 sc1
    v_add_f32 v241, v241, v239
    v_mfma_f32_16x16x32_bf16 a[204:207], v[220:223], a[188:191], a[204:207]
    s_mov_b32 s42, 0x53800000
    v_mov_b32 v239, v241
    v_mfma_f32_16x16x32_bf16 v[132:135], v[200:203], a[220:223], v[132:135]
    s_waitcnt lgkmcnt(6)
    v_mfma_f32_16x16x32_bf16 v[136:139], v[200:203], a[224:227], v[136:139]
    buffer_store_dwordx4 a[52:55], v247, s[20:23], s28 offen offset:128 sc1
    v_permlane16_swap_b32 v241, v239
    v_mfma_f32_16x16x32_bf16 v[140:143], v[200:203], a[228:231], v[140:143]
    v_add_f32 v239, v241, v239
    v_mfma_f32_16x16x32_bf16 v[144:147], v[200:203], a[232:235], v[144:147]
    v_rcp_f32 v241, v239
    v_mfma_f32_16x16x32_bf16 v[148:151], v[200:203], a[236:239], v[148:151]
    buffer_store_dwordx4 a[64:67], v247, s[20:23], s28 offen offset:3200 sc1
    v_mfma_f32_16x16x32_bf16 v[152:155], v[200:203], a[240:243], v[152:155]
    v_cmp_nge_f32 vcc, s42, v239
    v_mfma_f32_16x16x32_bf16 v[156:159], v[200:203], a[244:247], v[156:159]
    v_mfma_f32_16x16x32_bf16 v[160:163], v[200:203], a[248:251], v[160:163]
    ds_write_b32 v248, v241 offset:0
    v_mfma_f32_16x16x32_bf16 v[164:167], v[200:203], a[252:255], v[164:167]
    ds_read_b128 v[204:207], v249 offset:0
    v_mfma_f32_16x16x32_bf16 v[168:171], v[200:203], a[0:3], v[168:171]
    s_waitcnt lgkmcnt(2)
    v_mfma_f32_16x16x32_bf16 v[172:175], v[200:203], a[4:7], v[172:175]
    buffer_store_dwordx4 a[56:59], v247, s[20:23], s28 offen offset:256 sc1
    v_mfma_f32_16x16x32_bf16 a[204:207], v[200:203], a[8:11], a[204:207]
    s_cmp_lg_u64 vcc, 0
    s_cselect_b32 s42, 1, 0
    s_lshl_b32 s42, s42, s51
    s_or_b32 s36, s36, s42
    buffer_store_dwordx4 a[68:71], v247, s[20:23], s28 offen offset:3328 sc1
    s_nop 3
    s_waitcnt lgkmcnt(0)
.p2align 3
    v_pk_mul_f32 v[132:133], v[132:133], v[204:205]
    v_pk_mul_f32 v[242:243], v[134:135], v[206:207]
    v_pk_mul_f32 v[134:135], v[136:137], v[204:205]
    v_pk_mul_f32 v[140:141], v[140:141], v[204:205]
    v_pk_mul_f32 v[144:145], v[144:145], v[204:205]
    v_cvt_pk_bf16_f32 v132, v132, v134
    v_cvt_pk_bf16_f32 v134, v133, v135
    v_cvt_pk_bf16_f32 v133, v140, v144
    v_cvt_pk_bf16_f32 v135, v141, v145
    ds_write_b128 v246, v[132:135] offset:18432
    v_pk_mul_f32 v[138:139], v[138:139], v[206:207]
    v_pk_mul_f32 v[142:143], v[142:143], v[206:207]
    v_pk_mul_f32 v[146:147], v[146:147], v[206:207]
    v_cvt_pk_bf16_f32 v136, v242, v138
    v_cvt_pk_bf16_f32 v138, v243, v139
    v_cvt_pk_bf16_f32 v137, v142, v146
    v_cvt_pk_bf16_f32 v139, v143, v147
    ds_write_b128 v246, v[136:139] offset:18944
    ds_read_b64_tr_b16 a[72:73], v231 offset:18432
    ds_read_b64_tr_b16 a[74:75], v231 offset:18496
    ds_read_b64_tr_b16 a[84:85], v231 offset:21504
    ds_read_b64_tr_b16 a[86:87], v231 offset:21568
    v_pk_mul_f32 v[148:149], v[148:149], v[204:205]
    v_pk_mul_f32 v[242:243], v[150:151], v[206:207]
    v_pk_mul_f32 v[150:151], v[152:153], v[204:205]
    v_pk_mul_f32 v[156:157], v[156:157], v[204:205]
    v_pk_mul_f32 v[160:161], v[160:161], v[204:205]
    v_cvt_pk_bf16_f32 v148, v148, v150
    v_cvt_pk_bf16_f32 v150, v149, v151
    v_cvt_pk_bf16_f32 v149, v156, v160
    v_cvt_pk_bf16_f32 v151, v157, v161
    ds_write_b128 v246, v[148:151] offset:19456
    s_waitcnt lgkmcnt(1)
    s_mov_b32 s28, 18432
    buffer_store_dwordx4 a[72:75], v247, s[20:23], s28 offen offset:0 sc1
    buffer_store_dwordx4 a[84:87], v247, s[20:23], s28 offen offset:3072 sc1
.p2align 3
    v_pk_mul_f32 v[154:155], v[154:155], v[206:207]
    v_pk_mul_f32 v[158:159], v[158:159], v[206:207]
    v_pk_mul_f32 v[162:163], v[162:163], v[206:207]
    v_cvt_pk_bf16_f32 v152, v242, v154
    v_cvt_pk_bf16_f32 v154, v243, v155
    v_cvt_pk_bf16_f32 v153, v158, v162
    v_cvt_pk_bf16_f32 v155, v159, v163
    ds_write_b128 v246, v[152:155] offset:19968
    ds_read_b64_tr_b16 a[76:77], v231 offset:19456
    ds_read_b64_tr_b16 a[78:79], v231 offset:19520
    ds_read_b64_tr_b16 a[88:89], v231 offset:22528
    ds_read_b64_tr_b16 a[90:91], v231 offset:22592
    v_accvgpr_read_b32 v160, a204
    v_accvgpr_read_b32 v161, a205
    v_accvgpr_read_b32 v162, a206
    v_accvgpr_read_b32 v163, a207
    v_pk_mul_f32 v[164:165], v[164:165], v[204:205]
    v_pk_mul_f32 v[242:243], v[166:167], v[206:207]
    v_pk_mul_f32 v[166:167], v[168:169], v[204:205]
    v_pk_mul_f32 v[172:173], v[172:173], v[204:205]
    v_pk_mul_f32 v[160:161], v[160:161], v[204:205]
    v_cvt_pk_bf16_f32 v164, v164, v166
    v_cvt_pk_bf16_f32 v166, v165, v167
    v_cvt_pk_bf16_f32 v165, v172, v160
    v_cvt_pk_bf16_f32 v167, v173, v161
    ds_write_b128 v246, v[164:167] offset:20480
    s_waitcnt lgkmcnt(1)
    buffer_store_dwordx4 a[76:79], v247, s[20:23], s28 offen offset:128 sc1
    buffer_store_dwordx4 a[88:91], v247, s[20:23], s28 offen offset:3200 sc1
.p2align 3
    v_pk_mul_f32 v[170:171], v[170:171], v[206:207]
    v_pk_mul_f32 v[174:175], v[174:175], v[206:207]
    v_pk_mul_f32 v[162:163], v[162:163], v[206:207]
    v_cvt_pk_bf16_f32 v168, v242, v170
    v_cvt_pk_bf16_f32 v170, v243, v171
    v_cvt_pk_bf16_f32 v169, v174, v162
    v_cvt_pk_bf16_f32 v171, v175, v163
    ds_write_b128 v246, v[168:171] offset:20992
    ds_read_b64_tr_b16 a[80:81], v231 offset:20480
    ds_read_b64_tr_b16 a[82:83], v231 offset:20544
    ds_read_b64_tr_b16 a[92:93], v231 offset:23552
    ds_read_b64_tr_b16 a[94:95], v231 offset:23616
    s_waitcnt lgkmcnt(0)
    buffer_store_dwordx4 a[80:83], v247, s[20:23], s28 offen offset:256 sc1
    buffer_store_dwordx4 a[92:95], v247, s[20:23], s28 offen offset:3328 sc1
    s_cmp_lg_u32 s52, 0
    s_cbranch_scc1 L_todo
    v_mov_b32 v0, s36
    s_lshl_b32 s38, s24, 2
    s_add_u32 s38, s38, 159744
    v_mov_b32 v1, s38
    ds_write_b32 v1, v0
    s_waitcnt lgkmcnt(0)
    s_barrier
    v_mov_b32 v1, 159744
    ds_read_b128 v[4:7], v1
    s_waitcnt lgkmcnt(0)
    v_or_b32 v4, v4, v5
    v_or3_b32 v4, v4, v6, v7
    s_nop 1
    v_readfirstlane_b32 s53, v4
    s_mov_b32 s52, 1
    s_nop 3
L_todo:
    s_and_b32 s53, s53, 7
    s_cbranch_scc0 L_fin
    s_ff1_i32_b32 s51, s53
    s_bitset0_b32 s53, s51
    s_lshl_b32 s32, s51, 5
    s_add_u32 s32, s32, s50
    s_mov_b32 s31, 1
    s_waitcnt vmcnt(0) lgkmcnt(0)
    s_barrier
    s_branch L_run
L_fin:
L_end:
    s_endpgm
L_max:
    v_and_b32 v4, 15, v251
    v_lshrrev_b32 v5, 4, v251
    v_mul_u32_u24 v6, 384, v4
    v_lshl_add_u32 v6, v5, 4, v6
    s_mul_i32 s39, s32, 98304
    s_mul_i32 s40, s24, 24576
    s_add_u32 s39, s39, s40
    s_add_u32 s20, s46, s39
    s_addc_u32 s21, s47, 0
    s_mov_b32 s22, 24576
    s_mov_b32 s43, 0
    buffer_load_dwordx4 a[0:3], v6, s[20:23], s43 offen offset:0
    buffer_load_dwordx4 a[4:7], v6, s[20:23], s43 offen offset:64
    buffer_load_dwordx4 a[8:11], v6, s[20:23], s43 offen offset:128
    buffer_load_dwordx4 a[12:15], v6, s[20:23], s43 offen offset:192
    buffer_load_dwordx4 a[16:19], v6, s[20:23], s43 offen offset:256
    buffer_load_dwordx4 a[20:23], v6, s[20:23], s43 offen offset:320
    s_mov_b32 s43, 6144
    buffer_load_dwordx4 a[24:27], v6, s[20:23], s43 offen offset:0
    buffer_load_dwordx4 a[28:31], v6, s[20:23], s43 offen offset:64
    buffer_load_dwordx4 a[32:35], v6, s[20:23], s43 offen offset:128
    buffer_load_dwordx4 a[36:39], v6, s[20:23], s43 offen offset:192
    buffer_load_dwordx4 a[40:43], v6, s[20:23], s43 offen offset:256
    buffer_load_dwordx4 a[44:47], v6, s[20:23], s43 offen offset:320
    s_mov_b32 s43, 12288
    buffer_load_dwordx4 a[48:51], v6, s[20:23], s43 offen offset:0
    buffer_load_dwordx4 a[52:55], v6, s[20:23], s43 offen offset:64
    buffer_load_dwordx4 a[56:59], v6, s[20:23], s43 offen offset:128
    buffer_load_dwordx4 a[60:63], v6, s[20:23], s43 offen offset:192
    buffer_load_dwordx4 a[64:67], v6, s[20:23], s43 offen offset:256
    buffer_load_dwordx4 a[68:71], v6, s[20:23], s43 offen offset:320
    s_mov_b32 s43, 18432
    buffer_load_dwordx4 a[72:75], v6, s[20:23], s43 offen offset:0
    buffer_load_dwordx4 a[76:79], v6, s[20:23], s43 offen offset:64
    buffer_load_dwordx4 a[80:83], v6, s[20:23], s43 offen offset:128
    buffer_load_dwordx4 a[84:87], v6, s[20:23], s43 offen offset:192
    buffer_load_dwordx4 a[88:91], v6, s[20:23], s43 offen offset:256
    buffer_load_dwordx4 a[92:95], v6, s[20:23], s43 offen offset:320
    s_mul_hi_u32 s43, s32, 0x55555556
    s_mul_i32 s43, s43, 196608
    s_mov_b32 s44, 16
    s_mov_b32 s20, s6
    s_mov_b32 s21, s7
    s_mov_b32 s22, 50331648
L_maxloop:
    buffer_load_dwordx4 a[96:99], v6, s[20:23], s43 offen offset:0
    buffer_load_dwordx4 a[100:103], v6, s[20:23], s43 offen offset:64
    buffer_load_dwordx4 a[104:107], v6, s[20:23], s43 offen offset:128
    buffer_load_dwordx4 a[108:111], v6, s[20:23], s43 offen offset:192
    buffer_load_dwordx4 a[112:115], v6, s[20:23], s43 offen offset:256
    buffer_load_dwordx4 a[116:119], v6, s[20:23], s43 offen offset:320
    s_add_u32 s43, s43, 6144
    buffer_load_dwordx4 a[120:123], v6, s[20:23], s43 offen offset:0
    buffer_load_dwordx4 a[124:127], v6, s[20:23], s43 offen offset:64
    buffer_load_dwordx4 a[128:131], v6, s[20:23], s43 offen offset:128
    buffer_load_dwordx4 a[132:135], v6, s[20:23], s43 offen offset:192
    buffer_load_dwordx4 a[136:139], v6, s[20:23], s43 offen offset:256
    buffer_load_dwordx4 a[140:143], v6, s[20:23], s43 offen offset:320
    s_add_u32 s43, s43, 6144
    s_waitcnt vmcnt(0)
    v_mfma_f32_16x16x32_bf16 v[176:179], a[96:99], a[0:3], 0
    v_mfma_f32_16x16x32_bf16 v[176:179], a[100:103], a[4:7], v[176:179]
    v_mfma_f32_16x16x32_bf16 v[176:179], a[104:107], a[8:11], v[176:179]
    v_mfma_f32_16x16x32_bf16 v[176:179], a[108:111], a[12:15], v[176:179]
    v_mfma_f32_16x16x32_bf16 v[176:179], a[112:115], a[16:19], v[176:179]
    v_mfma_f32_16x16x32_bf16 v[176:179], a[116:119], a[20:23], v[176:179]
    v_mfma_f32_16x16x32_bf16 v[180:183], a[120:123], a[0:3], 0
    v_mfma_f32_16x16x32_bf16 v[180:183], a[124:127], a[4:7], v[180:183]
    v_mfma_f32_16x16x32_bf16 v[180:183], a[128:131], a[8:11], v[180:183]
    v_mfma_f32_16x16x32_bf16 v[180:183], a[132:135], a[12:15], v[180:183]
    v_mfma_f32_16x16x32_bf16 v[180:183], a[136:139], a[16:19], v[180:183]
    v_mfma_f32_16x16x32_bf16 v[180:183], a[140:143], a[20:23], v[180:183]
    v_mfma_f32_16x16x32_bf16 v[184:187], a[96:99], a[24:27], 0
    v_mfma_f32_16x16x32_bf16 v[184:187], a[100:103], a[28:31], v[184:187]
    v_mfma_f32_16x16x32_bf16 v[184:187], a[104:107], a[32:35], v[184:187]
    v_mfma_f32_16x16x32_bf16 v[184:187], a[108:111], a[36:39], v[184:187]
    v_mfma_f32_16x16x32_bf16 v[184:187], a[112:115], a[40:43], v[184:187]
    v_mfma_f32_16x16x32_bf16 v[184:187], a[116:119], a[44:47], v[184:187]
    v_mfma_f32_16x16x32_bf16 v[188:191], a[120:123], a[24:27], 0
    v_mfma_f32_16x16x32_bf16 v[188:191], a[124:127], a[28:31], v[188:191]
    v_mfma_f32_16x16x32_bf16 v[188:191], a[128:131], a[32:35], v[188:191]
    v_mfma_f32_16x16x32_bf16 v[188:191], a[132:135], a[36:39], v[188:191]
    v_mfma_f32_16x16x32_bf16 v[188:191], a[136:139], a[40:43], v[188:191]
    v_mfma_f32_16x16x32_bf16 v[188:191], a[140:143], a[44:47], v[188:191]
    v_mfma_f32_16x16x32_bf16 v[192:195], a[96:99], a[48:51], 0
    v_mfma_f32_16x16x32_bf16 v[192:195], a[100:103], a[52:55], v[192:195]
    v_mfma_f32_16x16x32_bf16 v[192:195], a[104:107], a[56:59], v[192:195]
    v_mfma_f32_16x16x32_bf16 v[192:195], a[108:111], a[60:63], v[192:195]
    v_mfma_f32_16x16x32_bf16 v[192:195], a[112:115], a[64:67], v[192:195]
    v_mfma_f32_16x16x32_bf16 v[192:195], a[116:119], a[68:71], v[192:195]
    v_mfma_f32_16x16x32_bf16 v[196:199], a[120:123], a[48:51], 0
    v_mfma_f32_16x16x32_bf16 v[196:199], a[124:127], a[52:55], v[196:199]
    v_mfma_f32_16x16x32_bf16 v[196:199], a[128:131], a[56:59], v[196:199]
    v_mfma_f32_16x16x32_bf16 v[196:199], a[132:135], a[60:63], v[196:199]
    v_mfma_f32_16x16x32_bf16 v[196:199], a[136:139], a[64:67], v[196:199]
    v_mfma_f32_16x16x32_bf16 v[196:199], a[140:143], a[68:71], v[196:199]
    v_mfma_f32_16x16x32_bf16 v[200:203], a[96:99], a[72:75], 0
    v_mfma_f32_16x16x32_bf16 v[200:203], a[100:103], a[76:79], v[200:203]
    v_mfma_f32_16x16x32_bf16 v[200:203], a[104:107], a[80:83], v[200:203]
    v_mfma_f32_16x16x32_bf16 v[200:203], a[108:111], a[84:87], v[200:203]
    v_mfma_f32_16x16x32_bf16 v[200:203], a[112:115], a[88:91], v[200:203]
    v_mfma_f32_16x16x32_bf16 v[200:203], a[116:119], a[92:95], v[200:203]
    v_mfma_f32_16x16x32_bf16 v[204:207], a[120:123], a[72:75], 0
    v_mfma_f32_16x16x32_bf16 v[204:207], a[124:127], a[76:79], v[204:207]
    v_mfma_f32_16x16x32_bf16 v[204:207], a[128:131], a[80:83], v[204:207]
    v_mfma_f32_16x16x32_bf16 v[204:207], a[132:135], a[84:87], v[204:207]
    v_mfma_f32_16x16x32_bf16 v[204:207], a[136:139], a[88:91], v[204:207]
    v_mfma_f32_16x16x32_bf16 v[204:207], a[140:143], a[92:95], v[204:207]
    s_nop 7
    v_max3_f32 v232, v232, v176, v177
    v_max3_f32 v232, v232, v178, v179
    v_max3_f32 v232, v232, v180, v181
    v_max3_f32 v232, v232, v182, v183
    v_max3_f32 v233, v233, v184, v185
    v_max3_f32 v233, v233, v186, v187
    v_max3_f32 v233, v233, v188, v189
    v_max3_f32 v233, v233, v190, v191
    v_max3_f32 v234, v234, v192, v193
    v_max3_f32 v234, v234, v194, v195
    v_max3_f32 v234, v234, v196, v197
    v_max3_f32 v234, v234, v198, v199
    v_max3_f32 v235, v235, v200, v201
    v_max3_f32 v235, v235, v202, v203
    v_max3_f32 v235, v235, v204, v205
    v_max3_f32 v235, v235, v206, v207
    s_sub_u32 s44, s44, 1
    s_cmp_lg_u32 s44, 0
    s_cbranch_scc1 L_maxloop
    s_mov_b32 s20, s48
    s_mov_b32 s21, s49
    s_mov_b32 s22, 0
    s_branch L_k0
.fill 2048, 4, 0xbf810000
L_last:
    s_endpgm
.set CODE_BYTES, L_last - L_pc
.section .rodata,"a"
.p2align 6
.amdhsa_kernel standalone__gqa_softmax__near_ridge_kernel
  .amdhsa_next_free_vgpr 512
  .amdhsa_next_free_sgpr 102
  .amdhsa_accum_offset 256
  .amdhsa_group_segment_fixed_size 0
  .amdhsa_kernarg_size 48
  .amdhsa_user_sgpr_count 2
  .amdhsa_user_sgpr_kernarg_segment_ptr 1
  .amdhsa_system_sgpr_workgroup_id_x 1
.end_amdhsa_kernel
```
